```python
import torch

def _softmax(x, axis=-1):
    return torch.softmax(x, dim=axis)

def _gelu(x):
    return torch.nn.functional.gelu(x, approximate='tanh')

def _silu(x):
    return torch.nn.functional.silu(x)

def _sigmoid(x):
    return torch.sigmoid(x)

def _layernorm(x, axis=-1, eps=1e-05):
    m = x.mean(dim=axis, keepdim=True)
    v = x.var(dim=axis, keepdim=True, unbiased=False)
    return (x - m) / torch.sqrt(v + eps)

def _scatter_add(tgt, idx, src, axis=0):
    return tgt.clone().index_add_(axis, idx, src)

def _segment_sum(src, seg, n):
    out = torch.zeros((n,) + src.shape[1:], dtype=src.dtype)
    return out.index_add_(0, seg, src)

def _pad(x, pw):
    flat = tuple((v for pair in reversed(pw) for v in pair))
    return torch.nn.functional.pad(x, flat)
kernel_name = 'adaLN_cond__sliding_block_cached__geglu_ffn__decode'

def setup_inputs():

    _w = lambda a: (lambda t: t.to(torch.bfloat16) if t.is_floating_point() else t)(torch.as_tensor(a))

    def _A_setup():
        B, Sq, D = (1, 1, 448)
        Hq, Hkv, Sk, Dh = (16, 8, 32768, 256)
        assert Hq % Hkv == 0, (Hq, Hkv)
        return {'x': _w((lambda *s: torch.randn(*s, dtype=torch.bfloat16) * 0.05)(B, Sq, D)), 'k_cache': _w((lambda *s: torch.randn(*s, dtype=torch.bfloat16) * 3.2)(B, Hkv, Sk, Dh)), 'v_cache': _w((lambda *s: torch.randn(*s, dtype=torch.bfloat16) * 0.4)(B, Hkv, Sk, Dh)), 'wq': _w((lambda *s: torch.randn(*s, dtype=torch.bfloat16) * 3.2)(D, Hq * Dh) * D ** (-0.5)), 'wo': _w((lambda *s: torch.randn(*s, dtype=torch.bfloat16) * 0.4)(Hq * Dh, D) * (Hq * Dh) ** (-0.5))}
    _A_in = _A_setup()

    def _B_setup():
        B, S, D, F = (1, 1, 448, 1792)
        return {'x': _w((lambda *s: torch.randn(*s, dtype=torch.bfloat16) * 0.05)(B, S, D)), 'w_gate': _w((lambda *s: torch.randn(*s, dtype=torch.bfloat16) * 0.05)(D, F)), 'w_up': _w((lambda *s: torch.randn(*s, dtype=torch.bfloat16) * 0.05)(D, F)), 'w_down': _w((lambda *s: torch.randn(*s, dtype=torch.bfloat16) * 0.05)(F, D))}
    _B_in = _B_setup()
    return {'A_x': _A_in['x'], 'A_k_cache': _A_in['k_cache'], 'A_v_cache': _A_in['v_cache'], 'A_wq': _A_in['wq'], 'A_wo': _A_in['wo'], 'B_x': _B_in['x'], 'B_w_gate': _B_in['w_gate'], 'B_w_up': _B_in['w_up'], 'B_w_down': _B_in['w_down'], 'c': _w((lambda *s: torch.randn(*s, dtype=torch.bfloat16) * 0.1)(1, 448) * 8.0), 'w_mod': _w((lambda *s: torch.randn(*s, dtype=torch.bfloat16) * 0.1)(448, 6 * 448) * 448 ** (-0.5) * 8.0)}

def reference(A_x, A_k_cache, A_v_cache, A_wq, A_wo, B_x, B_w_gate, B_w_up, B_w_down, c, w_mod):

    def _A_ref(x, k_cache, v_cache, wq, wo):
        B, Sq, D = x.shape
        Hq, Dh = (16, 256)
        Hkv, Sk = (k_cache.shape[1], k_cache.shape[2])
        W = min(4096, max(256, Sk // 4))
        rep = Hq // Hkv
        q = (lambda x, *d: x.permute(*d))((x @ wq).reshape(B, Sq, Hq, Dh), 0, 2, 1, 3)
        k = (lambda x, n, axis: torch.repeat_interleave(x, n, dim=axis))(k_cache[:, :, Sk - W:, :], rep, axis=1)
        v = (lambda x, n, axis: torch.repeat_interleave(x, n, dim=axis))(v_cache[:, :, Sk - W:, :], rep, axis=1)
        scores = torch.einsum('bhqd,bhkd->bhqk', q, k) * Dh ** (-0.5)
        p = _softmax(scores, axis=-1)
        o = torch.einsum('bhqk,bhkd->bhqd', p, v)
        return (lambda x, *d: x.permute(*d))(o, 0, 2, 1, 3).reshape(B, Sq, Hq * Dh) @ wo

    def _B_ref(x, w_gate, w_up, w_down):
        return _gelu(x @ w_gate) * (x @ w_up) @ w_down
    x = A_x
    mod = (_silu(c) @ w_mod).reshape(c.shape[0], 6, 1, -1)
    sa, ca, ga, sb, cb, gb = (mod[:, 0].clone(), mod[:, 1].clone(), mod[:, 2].clone(), mod[:, 3].clone(), mod[:, 4].clone(), mod[:, 5].clone())
    h = _layernorm(x, axis=-1) * (1 + ca) + sa
    x = x + ga * _A_ref(h, A_k_cache, A_v_cache, A_wq, A_wo)
    h = _layernorm(x, axis=-1) * (1 + cb) + sb
    x = x + gb * _B_ref(h, B_w_gate, B_w_up, B_w_down)
    return x
```

```asm
; @launch grid=(256,1,1) block=(512,1,1) lds=157440
.amdgcn_target "amdgcn-amd-amdhsa--gfx950"
.text
.p2align 9
.fill 64, 4, 0xbf810000
.globl adaLN_cond__sliding_block_cached__geglu_ffn__decode_kernel
.p2align 8
.type adaLN_cond__sliding_block_cached__geglu_ffn__decode_kernel,@function
adaLN_cond__sliding_block_cached__geglu_ffn__decode_kernel:
s_load_dwordx16 s[64:79], s[0:1], 0
s_load_dwordx8 s[80:87], s[0:1], 64
s_load_dwordx2 s[8:9], s[0:1], 104
v_lshrrev_b32 v1, 6, v0
s_cmpk_ge_u32 s2, 256
v_readfirstlane_b32 s4, v1
s_cbranch_scc1 L_end
s_getpc_b64 s[16:17]
L_pc:
v_lshlrev_b32 v3, 7, v0
s_mov_b32 s18, L_codeend-L_pc
s_mov_b32 s19, 0x20000
buffer_load_dword v249, v3, s[16:19], 0 offen
s_cmp_lg_u32 s4, 0
s_cbranch_scc1 L_worker
v_and_b32 v0, 63, v0
s_and_b32 s5, s2, 7
s_lshr_b32 s6, s2, 5
s_lshr_b32 s3, s2, 3
s_add_u32 s7, s3, s6
s_and_b32 s7, s7, 3
v_lshlrev_b32 v1, 4, v0
v_mov_b32 v2, 147456
s_and_b32 s47, s5, 3
s_mul_i32 s48, s47, 112
s_cmp_lt_u32 s6, 7
s_cselect_b32 s40, 1, 0
s_cmp_eq_u32 s7, 3
s_cselect_b32 s40, s40, 0
s_lshl2_add_u32 s48, s3, s48
s_mulk_i32 s48, 5376
s_lshr_b32 s44, s5, 2
s_mulk_i32 s44, 896
s_add_u32 s48, s48, s44
s_brev_b32 s44, 2
s_cmp_ge_u32 s3, 28
s_cselect_b32 s48, s44, s48
v_cmp_gt_u32 vcc, 56, v0
v_mov_b32 v3, s44
s_mov_b32 s22, 2408448
s_mov_b32 s23, s19
v_cndmask_b32 v3, v3, v1, vcc
s_lshl_b32 s36, s5, 6
s_add_u32 s36, s36, s6
s_lshl_b32 s36, s36, 18
s_mul_i32 s37, s7, 90112
s_add_u32 s36, s36, s37
s_add_u32 s36, s36, 14589952
s_mov_b32 m0, 0
s_brev_b32 s18, 16
v_mov_b64 v[4:5], 0
v_mov_b64 v[6:7], 0
v_add_u32 v10, v2, v1
ds_write_b128 v10, v[4:7]
ds_write_b128 v10, v[4:7] offset:4608
v_lshl_add_u32 v5, v0, 2, v2
v_mov_b32 v8, -23
v_mov_b32 v14, v1
s_mov_b32 s37, s36
s_mov_b32 s39, 1
s_mov_b32 s45, 1
s_waitcnt lgkmcnt(0)
s_mov_b64 s[20:21], s[84:85]
s_mov_b64 s[16:17], s[66:67]
buffer_load_dwordx4 v[240:243], v3, s[20:23], s48 offen
s_addk_i32 s48, 5376
buffer_load_dwordx4 v[240:243], v3, s[20:23], s48 offen
s_addk_i32 s48, 5376
buffer_load_dwordx4 v[240:243], v3, s[20:23], s48 offen
s_addk_i32 s48, 5376
buffer_load_dwordx4 v[240:243], v3, s[20:23], s48 offen
s_cmp_eq_u32 s7, 0
s_cbranch_scc1 L_ld_q
s_cmp_eq_u32 s40, 0
s_cbranch_scc1 L_ld_k0
s_barrier
s_mov_b32 s45, 0
s_mov_b32 s39, 11
s_branch L_ld_k1
L_ld_k0:
buffer_load_dwordx4 v14, s[16:19], s36 offen offset:0 nt lds
s_waitcnt vmcnt(23)
v_xor_b32 v4, 16, v14
buffer_load_dwordx4 v4, s[16:19], s36 offen offset:1024 nt lds
s_waitcnt vmcnt(23)
v_xor_b32 v4, 32, v14
buffer_load_dwordx4 v4, s[16:19], s36 offen offset:2048 nt lds
s_waitcnt vmcnt(23)
v_xor_b32 v4, 48, v14
buffer_load_dwordx4 v4, s[16:19], s36 offen offset:3072 nt lds
s_addk_i32 m0, 4096
s_addk_i32 s36, 4096
v_add_u32 v8, 4, v8
s_waitcnt vmcnt(23)
ds_write_b32 v5, v8
v_xor_b32 v4, 64, v14
buffer_load_dwordx4 v4, s[16:19], s36 offen offset:0 nt lds
s_waitcnt vmcnt(23)
v_xor_b32 v4, 80, v14
buffer_load_dwordx4 v4, s[16:19], s36 offen offset:1024 nt lds
s_waitcnt vmcnt(23)
v_xor_b32 v4, 96, v14
buffer_load_dwordx4 v4, s[16:19], s36 offen offset:2048 nt lds
s_waitcnt vmcnt(23)
v_xor_b32 v4, 112, v14
buffer_load_dwordx4 v4, s[16:19], s36 offen offset:3072 nt lds
s_addk_i32 m0, 4096
s_addk_i32 s36, 4096
v_add_u32 v8, 4, v8
v_xor_b32 v14, 0x80, v14
s_waitcnt vmcnt(23)
ds_write_b32 v5, v8
s_cmp_eq_u32 s45, 0
s_cbranch_scc1 L_ld_nb
s_barrier
s_mov_b32 s45, 0
L_ld_nb:
s_sub_u32 s39, s39, 1
s_cmp_lg_u32 s39, 0
s_cbranch_scc1 L_ld_k0
s_lshr_b32 s39, s7, 1
s_and_b32 s39, s39, s7
s_sub_u32 s39, 11, s39
L_ld_k1:
s_brev_b32 s10, 4
s_mov_b32 s11, 0x20000
s_movk_i32 s15, 88
s_cmp_eq_u32 s7, 3
s_cselect_b32 s15, 80, s15
s_setprio 3
v_subrev_u32 v8, 4, v8
s_sub_u32 s39, s39, 1
L_ld_k:
buffer_load_dwordx4 v14, s[16:19], s36 offen offset:0 nt lds
s_waitcnt vmcnt(27)
v_xor_b32 v4, 16, v14
buffer_load_dwordx4 v4, s[16:19], s36 offen offset:1024 nt lds
s_waitcnt vmcnt(27)
v_xor_b32 v4, 32, v14
buffer_load_dwordx4 v4, s[16:19], s36 offen offset:2048 nt lds
s_waitcnt vmcnt(27)
v_xor_b32 v4, 48, v14
buffer_load_dwordx4 v4, s[16:19], s36 offen offset:3072 nt lds
s_addk_i32 m0, 4096
s_addk_i32 s36, 4096
v_add_u32 v8, 4, v8
s_waitcnt vmcnt(27)
ds_write_b32 v5, v8
v_xor_b32 v4, 64, v14
buffer_load_dwordx4 v4, s[16:19], s36 offen offset:0 nt lds
s_waitcnt vmcnt(27)
v_xor_b32 v4, 80, v14
buffer_load_dwordx4 v4, s[16:19], s36 offen offset:1024 nt lds
s_waitcnt vmcnt(27)
v_xor_b32 v4, 96, v14
buffer_load_dwordx4 v4, s[16:19], s36 offen offset:2048 nt lds
s_waitcnt vmcnt(27)
v_xor_b32 v4, 112, v14
buffer_load_dwordx4 v4, s[16:19], s36 offen offset:3072 nt lds
s_addk_i32 m0, 4096
s_addk_i32 s36, 4096
v_add_u32 v8, 4, v8
v_xor_b32 v14, 0x80, v14
s_waitcnt vmcnt(27)
ds_write_b32 v5, v8
s_sub_u32 s39, s39, 1
s_cmp_lg_u32 s39, 0
s_cbranch_scc1 L_ld_k
s_branch L_ld_rest
L_worker:
v_and_b32 v0, 63, v0
s_and_b32 s5, s2, 7
s_lshr_b32 s6, s2, 5
s_lshr_b32 s3, s2, 3
s_add_u32 s7, s3, s6
s_and_b32 s7, s7, 3
v_lshlrev_b32 v1, 4, v0
v_mov_b32 v2, 147456
s_and_b32 s47, s5, 3
s_mul_i32 s48, s47, 112
s_cmp_lt_u32 s6, 7
s_cselect_b32 s40, 1, 0
s_cmp_eq_u32 s7, 3
s_cselect_b32 s40, s40, 0
s_sub_u32 s13, s4, 1
s_lshr_b32 s41, s5, 2
s_mul_i32 s41, s41, 7
s_add_u32 s41, s41, s6
s_lshl_b32 s43, s13, 7
v_lshlrev_b32 v18, 1, v0
s_lshl_b32 s45, s5, 10
s_mul_i32 s46, s3, 7
s_add_u32 s46, s46, s13
s_lshl_b32 s46, s46, 14
s_add_u32 s46, s46, s45
s_movk_i32 s22, 896
s_mov_b32 s23, s19
s_movk_i32 s26, 896
s_mov_b32 s27, s19
s_mov_b32 s30, 3670016
s_mov_b32 s31, s19
v_bfe_u32 v3, v0, 4, 1
v_lshlrev_b32 v3, 1, v3
v_and_b32 v4, 7, v0
v_xor_b32 v3, v3, v4
v_lshlrev_b32 v9, 4, v3
s_lshl_b32 s36, s13, 5
s_add_u32 s36, s36, s48
s_mulk_i32 s36, 5376
s_lshl_b32 s37, s41, 7
s_add_u32 s49, s36, s37
s_lshl_b32 s38, s6, 7
s_add_u32 s37, s45, s38
s_lshl_b32 s38, s13, 19
s_add_u32 s37, s37, s38
s_lshl_b32 s38, s13, 12
s_add_u32 s39, s38, 90112
s_lshl_b32 s38, s13, 13
s_brev_b32 s51, 2
s_cmp_eq_u32 s4, 4
s_cselect_b32 s51, s51, 0
s_movk_i32 s44, 5376
s_cmp_eq_u32 s7, 0
s_cselect_b32 s49, s37, s49
s_cselect_b32 m0, s38, s39
s_cselect_b32 s44, 8192, s44
s_cselect_b32 s39, 4, 2
s_cselect_b32 s51, 0, s51
s_mul_i32 s18, s44, 448
v_lshrrev_b32 v3, 3, v0
v_mul_u32_u24 v6, s44, v3
v_add_u32 v6, v6, v9
v_xor_b32 v7, 64, v6
s_mul_i32 s44, s44, 8
s_waitcnt lgkmcnt(0)
s_cselect_b64 s[16:17], s[70:71], s[84:85]
s_mov_b64 s[20:21], s[82:83]
s_mov_b64 s[24:25], s[64:65]
s_mov_b64 s[28:29], s[70:71]
s_load_dword s12, s[8:9], 0
s_cbranch_scc1 L_w_e0
s_cmp_eq_u32 s40, 0
s_cbranch_scc1 L_w_e2
L_w_e0:
buffer_load_ushort v19, v18, s[20:23], s43 offen
buffer_load_dwordx4 v[32:35], v1, s[24:27], 0 offen
s_cmp_eq_u32 s7, 0
s_cbranch_scc1 L_w_e2
s_cmp_gt_u32 s4, 4
s_cbranch_scc1 L_w_e2
L_w_e1:
buffer_load_dwordx4 v6, s[16:19], s49 offen nt lds
s_add_u32 m0, m0, 1024
s_add_u32 s49, s49, s44
buffer_load_dwordx4 v7, s[16:19], s49 offen nt lds
s_add_u32 m0, m0, 1024
s_add_u32 s49, s49, s44
s_add_u32 s49, s49, s51
s_sub_u32 s39, s39, 1
s_cmp_lg_u32 s39, 0
s_cbranch_scc1 L_w_e1
L_w_e2:
buffer_load_dwordx4 v[240:243], v1, s[28:31], s46 offen
s_add_u32 s46, s46, 8192
buffer_load_dwordx4 v[240:243], v1, s[28:31], s46 offen
s_barrier
s_lshl_b32 s42, s5, 5
s_add_u32 s42, s42, s3
s_lshl_b32 s50, s42, 7
s_mulk_i32 s42, 128
s_add_u32 s42, s42, 1310720
s_cmp_lt_u32 s4, 6
s_cbranch_scc1 L_w_t2
s_cmp_eq_u32 s4, 7
s_cbranch_scc1 L_w_t1
s_load_dword s96, s[8:9], s42 offset:0 glc
s_branch L_w_t2
L_w_t1:
s_load_dword s96, s[8:9], s50 offset:65536 glc
s_load_dword s96, s[8:9], s50 offset:98304
s_load_dword s96, s[8:9], s50 offset:131072
s_load_dword s96, s[8:9], s50 offset:163840 glc
s_and_b32 s50, s50, 0x1f80
s_load_dword s96, s[8:9], s50 offset:40960 glc
L_w_t2:
s_brev_b32 s10, 4
s_mov_b32 s11, 0x20000
s_movk_i32 s15, 88
s_cmp_eq_u32 s7, 3
s_cselect_b32 s15, 80, s15
v_mov_b32 v15, 1
v_and_b32 v16, 15, v0
v_lshrrev_b32 v17, 4, v0
v_mov_b32 v20, 2145299713
v_mov_b32 v21, 2145299713
v_mov_b32 v22, 2145299713
v_mov_b32 v23, 2145299713
v_lshrrev_b32 v3, 2, v16
v_lshl_add_u32 v3, v17, 3, v3
v_lshlrev_b32 v14, 7, v3
v_bfe_u32 v3, v0, 3, 2
v_bfe_u32 v4, v0, 1, 1
v_lshl_or_b32 v3, v3, 1, v4
v_lshl_add_u32 v14, v3, 4, v14
v_and_b32 v3, 1, v0
v_lshl_add_u32 v14, v3, 3, v14
v_lshl_add_u32 v25, v17, 4, v2
s_lshl_b32 s97, s5, 12
s_add_u32 s97, s97, 65536
v_and_b32 v3, 31, v0
v_lshlrev_b32 v198, 7, v3
s_cmp_eq_u32 s7, 0
s_cbranch_scc1 L_w_q
s_cmp_eq_u32 s40, 0
s_cbranch_scc1 L_w_b
s_lshl_b32 s36, s13, 5
v_xor_b32 v24, s36, v14
v_add_u32 v24, 90112, v24
s_lshl_b32 s36, s48, 1
v_add_u32 v26, s36, v25
v_and_b32 v3, 1, v0
v_cmp_eq_u32 s[50:51], 0, v3
v_lshlrev_b32 v8, 5, v17
v_lshl_add_u32 v8, v3, 4, v8
v_lshrrev_b32 v3, 1, v16
v_mul_u32_u24 v3, 28672, v3
v_add_u32 v8, v8, v3
s_mul_i32 s45, s47, 7168
s_lshl_b32 s37, s41, 9
s_add_u32 s45, s45, s37
s_add_u32 s45, s45, s43
s_add_u32 s45, s45, 1310720
s_cmp_le_u32 s4, 4
s_cbranch_scc1 L_w_a1
s_waitcnt vmcnt(3)
v_lshlrev_b32 v19, 16, v19
v_mul_f32 v4, 3216550459, v19
v_exp_f32 v4, v4
s_nop 0
v_add_f32 v4, 1.0, v4
v_rcp_f32 v4, v4
s_nop 0
v_mul_f32 v4, v19, v4
v_cvt_pk_bf16_f32 v4, v4, v4
v_add3_u32 v3, v18, s43, v2
ds_write_b16 v3, v4 offset:3712
s_mov_b64 exec, 1
ds_add_u32 v2, v15 offset:256
s_mov_b64 exec, -1
s_branch L_w_b
L_w_a1:
s_waitcnt vmcnt(7)
v_lshlrev_b32 v19, 16, v19
v_mul_f32 v4, 3216550459, v19
v_exp_f32 v4, v4
s_nop 0
v_add_f32 v4, 1.0, v4
v_rcp_f32 v4, v4
s_nop 0
v_mul_f32 v4, v19, v4
v_cvt_pk_bf16_f32 v4, v4, v4
v_add3_u32 v3, v18, s43, v2
ds_write_b16 v3, v4 offset:3712
s_waitcnt vmcnt(2)
s_mov_b64 exec, 1
ds_add_u32 v2, v15 offset:256
s_mov_b64 exec, -1
s_mov_b32 s14, 262144
L_wf_5:
ds_read_b32 v3, v2 offset:256
s_waitcnt lgkmcnt(0)
v_cmp_gt_i32 vcc, 7, v3
s_cbranch_vccz L_wd_6
s_sub_u32 s14, s14, 1
s_cbranch_scc0 L_wf_5
L_wd_6:
s_add_u32 s37, s12, 2654435769
v_mov_b32 v34, s37
v_mov_b32 v35, s37
ds_read_b64_tr_b16 v[64:65], v24 offset:0
ds_read_b64_tr_b16 v[66:67], v24 offset:512
ds_read_b64_tr_b16 v[68:69], v24 offset:4096
ds_read_b64_tr_b16 v[70:71], v24 offset:4608
ds_read_b64_tr_b16 v[72:73], v24 offset:8192
ds_read_b64_tr_b16 v[74:75], v24 offset:8704
ds_read_b64_tr_b16 v[76:77], v24 offset:12288
ds_read_b64_tr_b16 v[78:79], v24 offset:12800
ds_read_b128 v[128:131], v26 offset:3712
ds_read_b128 v[132:135], v26 offset:3776
ds_read_b128 v[136:139], v26 offset:3840
ds_read_b128 v[140:143], v26 offset:3904
s_mov_b64 exec, 1
ds_add_u32 v2, v15 offset:284
s_mov_b64 exec, -1
s_waitcnt lgkmcnt(0)
v_mfma_f32_16x16x32_bf16 v[28:31], v[64:67], v[128:131], 0
v_mfma_f32_16x16x32_bf16 v[28:31], v[68:71], v[132:135], v[28:31]
v_mfma_f32_16x16x32_bf16 v[28:31], v[72:75], v[136:139], v[28:31]
v_mfma_f32_16x16x32_bf16 v[28:31], v[76:79], v[140:143], v[28:31]
s_nop 7
v_cndmask_b32 v32, v30, v28, s[50:51]
v_cndmask_b32 v33, v31, v29, s[50:51]
s_mov_b32 exec_lo, 0x30003
s_mov_b32 exec_hi, 0x30003
buffer_store_dwordx4 v[32:35], v8, s[8:11], s45 offen sc1
s_mov_b64 exec, -1
s_branch L_w_b
L_w_q:
s_cmp_eq_u32 s4, 7
s_cbranch_scc1 L_w_q00
s_lshl_b32 s36, s5, 16
s_mul_i32 s37, s6, 6144
s_add_u32 s36, s36, s37
s_lshl_b32 s37, s13, 10
s_add_u32 s36, s36, s37
s_add_u32 s36, s36, 262144
buffer_store_dwordx4 v[20:23], v1, s[8:11], s36 offen sc1
s_branch L_w_q0
L_w_q00:
s_cmp_eq_u32 s6, 7
s_cbranch_scc1 L_w_q01
v_and_b32 v3, 1, v17
v_mul_u32_u24 v3, 1792, v3
v_lshrrev_b32 v4, 1, v17
v_mul_u32_u24 v4, 28672, v4
v_lshl_add_u32 v3, v16, 4, v3
v_add_u32 v3, v3, v4
s_mul_i32 s36, s5, 3584
s_lshl_b32 s37, s6, 8
s_add_u32 s36, s36, s37
s_add_u32 s36, s36, 983040
buffer_store_dwordx4 v[20:23], v3, s[8:11], s36 offen sc1
s_add_u32 s36, s36, 57344
buffer_store_dwordx4 v[20:23], v3, s[8:11], s36 offen sc1
s_add_u32 s36, s36, 57344
L_w_q01:
s_cmp_eq_u32 s5, 7
s_cbranch_scc1 L_w_q0
v_lshrrev_b32 v3, 3, v0
v_mul_u32_u24 v3, 7168, v3
v_and_b32 v4, 7, v0
v_lshl_add_u32 v3, v4, 4, v3
s_lshl_b32 s36, s5, 3
s_add_u32 s36, s36, s6
s_lshl_b32 s36, s36, 7
s_add_u32 s36, s36, 786432
s_add_u32 s37, s36, 57344
buffer_store_dwordx4 v[20:23], v3, s[8:11], s36 offen sc1
s_mov_b32 exec_hi, 0xffff
buffer_store_dwordx4 v[20:23], v3, s[8:11], s37 offen sc1
s_mov_b64 exec, -1
L_w_q0:
s_cmp_eq_u32 s4, 7
s_cbranch_scc1 L_w_qw7
s_waitcnt vmcnt(3)
L_w_qw7:
s_waitcnt vmcnt(6)
L_w_e1q:
buffer_load_dwordx4 v6, s[16:19], s49 offen nt lds
s_add_u32 m0, m0, 1024
s_add_u32 s49, s49, s44
buffer_load_dwordx4 v7, s[16:19], s49 offen nt lds
s_add_u32 m0, m0, 1024
s_add_u32 s49, s49, s44
s_add_u32 s49, s49, s51
s_sub_u32 s39, s39, 1
s_cmp_lg_u32 s39, 0
s_cbranch_scc1 L_w_e1q
v_and_b32 v3, 31, v0
v_lshlrev_b32 v3, 1, v3
s_lshl_b32 s36, s13, 6
v_add_u32 v3, s36, v3
v_lshrrev_b32 v4, 5, v0
v_add_u32 v24, v3, v4
v_lshl_add_u32 v24, v24, 1, v2
v_mul_u32_u24 v4, 7168, v4
v_lshl_add_u32 v26, v3, 3, v4
s_and_b32 s45, s5, 0
s_mul_i32 s45, s45, 28672
s_add_u32 s45, s45, 1310720
s_add_u32 s46, s45, 14336
s_lshl_b32 s36, s13, 5
v_xor_b32 v45, s36, v14
v_lshlrev_b32 v46, 4, v17
v_lshl_add_u32 v46, v16, 6, v46
s_lshl_b32 s49, s5, 12
s_lshl_b32 s36, s6, 9
s_add_u32 s49, s49, s36
s_add_u32 s49, s49, s43
s_add_u32 s49, s49, 131072
s_cmp_lg_u32 s4, 7
s_cbranch_scc1 L_w_qx
s_waitcnt vmcnt(8)
L_w_qx:
v_add_u32 v3, v2, v1
ds_write_b128 v3, v[32:35] offset:7168
ds_read_u16 v44, v24 offset:7168
v_lshlrev_b32 v19, 16, v19
v_mul_f32 v4, 3216550459, v19
v_exp_f32 v4, v4
s_nop 0
v_add_f32 v4, 1.0, v4
v_rcp_f32 v4, v4
s_nop 0
v_mul_f32 v4, v19, v4
v_cvt_pk_bf16_f32 v4, v4, v4
v_add3_u32 v3, v18, s43, v2
ds_write_b16 v3, v4 offset:3712
v_lshlrev_b32 v6, 16, v32
v_and_b32 v7, 0xffff0000, v32
v_lshlrev_b32 v8, 16, v33
v_and_b32 v9, 0xffff0000, v33
v_lshlrev_b32 v10, 16, v34
v_and_b32 v11, 0xffff0000, v34
v_lshlrev_b32 v12, 16, v35
v_and_b32 v13, 0xffff0000, v35
v_readfirstlane_b32 s36, v6
v_cmp_gt_u32 vcc, 56, v0
s_nop 0
v_mov_b32 v3, s36
v_cndmask_b32 v3, 0, v3, vcc
v_sub_f32 v6, v6, v3
v_sub_f32 v7, v7, v3
v_sub_f32 v8, v8, v3
v_sub_f32 v9, v9, v3
v_sub_f32 v10, v10, v3
v_sub_f32 v11, v11, v3
v_sub_f32 v12, v12, v3
v_sub_f32 v13, v13, v3
v_add_f32 v4, v6, v7
v_mul_f32 v5, v6, v6
v_fmac_f32 v5, v7, v7
v_add_f32 v4, v4, v8
v_fmac_f32 v5, v8, v8
v_add_f32 v4, v4, v9
v_fmac_f32 v5, v9, v9
v_add_f32 v4, v4, v10
v_fmac_f32 v5, v10, v10
v_add_f32 v4, v4, v11
v_fmac_f32 v5, v11, v11
v_add_f32 v4, v4, v12
v_fmac_f32 v5, v12, v12
v_add_f32 v4, v4, v13
v_fmac_f32 v5, v13, v13
s_waitcnt lgkmcnt(0)
v_lshlrev_b32 v44, 16, v44
v_add_f32_dpp v4, v4, v4 row_ror:1 row_mask:0xf bank_mask:0xf
v_add_f32_dpp v5, v5, v5 row_ror:1 row_mask:0xf bank_mask:0xf
s_nop 0
v_add_f32_dpp v4, v4, v4 row_ror:2 row_mask:0xf bank_mask:0xf
v_add_f32_dpp v5, v5, v5 row_ror:2 row_mask:0xf bank_mask:0xf
s_nop 0
v_add_f32_dpp v4, v4, v4 row_ror:4 row_mask:0xf bank_mask:0xf
v_add_f32_dpp v5, v5, v5 row_ror:4 row_mask:0xf bank_mask:0xf
s_nop 0
v_add_f32_dpp v4, v4, v4 row_ror:8 row_mask:0xf bank_mask:0xf
v_add_f32_dpp v5, v5, v5 row_ror:8 row_mask:0xf bank_mask:0xf
s_nop 0
v_add_f32_dpp v4, v4, v4 row_bcast:15 row_mask:0xa bank_mask:0xf
v_add_f32_dpp v5, v5, v5 row_bcast:15 row_mask:0xa bank_mask:0xf
s_nop 0
v_add_f32_dpp v4, v4, v4 row_bcast:31 row_mask:0xc bank_mask:0xf
v_add_f32_dpp v5, v5, v5 row_bcast:31 row_mask:0xc bank_mask:0xf
v_readlane_b32 s37, v4, 63
v_readlane_b32 s38, v5, 63
v_mov_b32 v6, 0x3b124925
v_mul_f32 v4, s37, v6
v_mul_f32 v5, s38, v6
v_fma_f32 v5, -v4, v4, v5
v_add_f32 v4, s36, v4
v_max_f32 v5, 0, v5
v_cvt_pk_bf16_f32 v5, 0, v5
v_cvt_pk_bf16_f32 v4, 0, v4
v_add_f32 v5, 0x3727c5ac, v5
v_sub_f32 v4, v44, v4
v_cvt_pk_bf16_f32 v5, 0, v5
v_sqrt_f32 v5, v5
v_cvt_pk_bf16_f32 v4, 0, v4
v_cvt_pk_bf16_f32 v5, 0, v5
v_rcp_f32 v5, v5
s_nop 0
v_mul_f32 v44, v4, v5
v_cvt_pk_bf16_f32 v44, 0, v44
s_add_u32 s12, s12, 2654435769
s_getreg_b32 s36, hwreg(HW_REG_XCC_ID, 0, 4)
s_andn2_b32 s48, s12, 15
s_or_b32 s48, s48, s36
s_waitcnt vmcnt(0)
s_mov_b64 exec, 1
ds_add_u32 v2, v15 offset:256
s_mov_b64 exec, -1
s_cmp_gt_u32 s4, 4
s_cbranch_scc1 L_w_q1
s_mov_b32 s14, 262144
L_wf_7:
ds_read_b32 v3, v2 offset:256
s_waitcnt lgkmcnt(0)
v_cmp_gt_i32 vcc, 7, v3
s_cbranch_vccz L_wd_8
s_sub_u32 s14, s14, 1
s_cbranch_scc0 L_wf_7
L_wd_8:
ds_read_b64_tr_b16 v[64:65], v45 offset:0
ds_read_b64_tr_b16 v[66:67], v45 offset:512
ds_read_b64_tr_b16 v[68:69], v45 offset:4096
ds_read_b64_tr_b16 v[70:71], v45 offset:4608
ds_read_b64_tr_b16 v[72:73], v45 offset:8192
ds_read_b64_tr_b16 v[74:75], v45 offset:8704
ds_read_b64_tr_b16 v[76:77], v45 offset:12288
ds_read_b64_tr_b16 v[78:79], v45 offset:12800
ds_read_b64_tr_b16 v[80:81], v45 offset:16384
ds_read_b64_tr_b16 v[82:83], v45 offset:16896
ds_read_b64_tr_b16 v[84:85], v45 offset:20480
ds_read_b64_tr_b16 v[86:87], v45 offset:20992
ds_read_b64_tr_b16 v[88:89], v45 offset:24576
ds_read_b64_tr_b16 v[90:91], v45 offset:25088
ds_read_b64_tr_b16 v[92:93], v45 offset:28672
ds_read_b64_tr_b16 v[94:95], v45 offset:29184
ds_read_b64_tr_b16 v[96:97], v45 offset:32768
ds_read_b64_tr_b16 v[98:99], v45 offset:33280
ds_read_b64_tr_b16 v[100:101], v45 offset:36864
ds_read_b64_tr_b16 v[102:103], v45 offset:37376
ds_read_b64_tr_b16 v[104:105], v45 offset:40960
ds_read_b64_tr_b16 v[106:107], v45 offset:41472
ds_read_b64_tr_b16 v[108:109], v45 offset:45056
ds_read_b64_tr_b16 v[110:111], v45 offset:45568
ds_read_b64_tr_b16 v[112:113], v45 offset:49152
ds_read_b64_tr_b16 v[114:115], v45 offset:49664
ds_read_b64_tr_b16 v[116:117], v45 offset:53248
ds_read_b64_tr_b16 v[118:119], v45 offset:53760
L_w_q1:
s_cmp_lg_u32 s4, 7
s_cbranch_scc1 L_w_ac1
s_mov_b32 s14, 262144
L_pl_9:
buffer_load_dword v47, v198, s[8:11], s97 offen sc1
s_waitcnt vmcnt(0)
v_xor_b32 v47, s48, v47
v_cmp_lt_u32 vcc, 15, v47
s_cbranch_vccz L_pd_10
s_sleep 1
s_sub_u32 s14, s14, 1
s_cbranch_scc0 L_pl_9
L_pd_10:
v_cmp_ne_u32 vcc, 0, v47
s_cbranch_vccnz L_w_ac1
ds_write_b32 v2, v15 offset:288
L_w_ac1:
s_lshl_b32 s38, s5, 5
s_add_u32 s38, s38, s6
s_lshl_b32 s38, s38, 7
s_add_u32 s38, s38, 163840
v_mov_b32 v34, s12
v_lshlrev_b32 v5, 2, v0
s_mov_b32 s14, 262144
L_wf_11:
ds_read_b32 v3, v2 offset:304
s_waitcnt lgkmcnt(0)
v_cmp_gt_i32 vcc, 1, v3
s_cbranch_vccz L_wd_12
s_sub_u32 s14, s14, 1
s_cbranch_scc0 L_wf_11
L_wd_12:
buffer_load_dwordx4 v[128:131], v26, s[8:11], s45 offen offset:0 sc1
buffer_load_dwordx4 v[132:135], v26, s[8:11], s46 offen offset:0 sc1
buffer_load_dwordx4 v[136:139], v26, s[8:11], s45 offen offset:3584 sc1
buffer_load_dwordx4 v[140:143], v26, s[8:11], s46 offen offset:3584 sc1
s_mov_b32 s14, 262144
s_waitcnt vmcnt(3)
v_cmp_ne_u32 vcc, s12, v130
s_nop 0
s_mov_b64 s[60:61], vcc
s_mov_b64 s[36:37], vcc
s_waitcnt vmcnt(2)
v_cmp_ne_u32 vcc, s12, v134
s_nop 0
s_mov_b64 s[62:63], vcc
s_or_b64 s[36:37], s[36:37], vcc
s_waitcnt vmcnt(1)
v_cmp_ne_u32 vcc, s12, v138
s_nop 0
s_mov_b64 s[64:65], vcc
s_or_b64 s[36:37], s[36:37], vcc
s_waitcnt vmcnt(0)
v_cmp_ne_u32 vcc, s12, v142
s_nop 0
s_mov_b64 s[66:67], vcc
s_or_b64 s[36:37], s[36:37], vcc
s_cmp_eq_u64 s[36:37], 0
s_cbranch_scc1 L_gd_15
L_g_13:
s_mov_b64 exec, s[60:61]
s_cbranch_execz L_gs_16
buffer_load_dwordx4 v[128:131], v26, s[8:11], s45 offen offset:0 sc1
L_gs_16:
s_mov_b64 exec, s[62:63]
s_cbranch_execz L_gs_17
buffer_load_dwordx4 v[132:135], v26, s[8:11], s46 offen offset:0 sc1
L_gs_17:
s_mov_b64 exec, s[64:65]
s_cbranch_execz L_gs_18
buffer_load_dwordx4 v[136:139], v26, s[8:11], s45 offen offset:3584 sc1
L_gs_18:
s_mov_b64 exec, s[66:67]
s_cbranch_execz L_gs_19
buffer_load_dwordx4 v[140:143], v26, s[8:11], s46 offen offset:3584 sc1
L_gs_19:
s_mov_b64 s[36:37], 0
s_waitcnt vmcnt(0)
s_mov_b64 exec, s[60:61]
s_cbranch_execz L_gs_20
v_cmp_ne_u32 vcc, s12, v130
s_nop 0
s_mov_b64 s[60:61], vcc
s_or_b64 s[36:37], s[36:37], vcc
L_gs_20:
s_mov_b64 exec, s[62:63]
s_cbranch_execz L_gs_21
v_cmp_ne_u32 vcc, s12, v134
s_nop 0
s_mov_b64 s[62:63], vcc
s_or_b64 s[36:37], s[36:37], vcc
L_gs_21:
s_mov_b64 exec, s[64:65]
s_cbranch_execz L_gs_22
v_cmp_ne_u32 vcc, s12, v138
s_nop 0
s_mov_b64 s[64:65], vcc
s_or_b64 s[36:37], s[36:37], vcc
L_gs_22:
s_mov_b64 exec, s[66:67]
s_cbranch_execz L_gs_23
v_cmp_ne_u32 vcc, s12, v142
s_nop 0
s_mov_b64 s[66:67], vcc
s_or_b64 s[36:37], s[36:37], vcc
L_gs_23:
s_mov_b64 exec, -1
s_cmp_eq_u64 s[36:37], 0
s_cbranch_scc1 L_gd_15
s_sub_u32 s14, s14, 1
s_cbranch_scc0 L_g_13
L_gd_15:
v_add_f32 v28, v128, v132
v_add_f32 v29, v129, v133
v_add_f32 v32, v136, v140
v_add_f32 v33, v137, v141
v_permlane32_swap_b32 v28, v29
s_nop 0
v_permlane32_swap_b32 v32, v33
v_add_f32 v28, v28, v29
v_add_f32 v32, v32, v33
L_x_a:
v_cvt_pk_bf16_f32 v32, 0, v32
v_cvt_pk_bf16_f32 v28, 0, v28
v_add_f32 v32, 1.0, v32
v_cvt_pk_bf16_f32 v32, 0, v32
v_mul_f32 v32, v44, v32
v_cvt_pk_bf16_f32 v32, 0, v32
v_add_f32 v32, v32, v28
v_cvt_pk_bf16_f32 v32, v32, v32
ds_write_b16 v24, v32 offset:2816
s_waitcnt lgkmcnt(0)
s_barrier
s_cmp_lg_u32 s4, 5
s_cbranch_scc1 L_w_q2
s_mov_b32 exec_hi, 0
buffer_store_dword v34, v5, s[8:11], s38 offen sc1
s_mov_b64 exec, -1
L_w_q2:
s_cmp_gt_u32 s4, 4
s_cbranch_scc1 L_w_ffn
ds_read_b32 v35, v2 offset:288
ds_read_b128 v[128:131], v25 offset:2816
ds_read_b128 v[132:135], v25 offset:2880
ds_read_b128 v[136:139], v25 offset:2944
ds_read_b128 v[140:143], v25 offset:3008
ds_read_b128 v[144:147], v25 offset:3072
ds_read_b128 v[148:151], v25 offset:3136
ds_read_b128 v[152:155], v25 offset:3200
ds_read_b128 v[156:159], v25 offset:3264
ds_read_b128 v[160:163], v25 offset:3328
ds_read_b128 v[164:167], v25 offset:3392
ds_read_b128 v[168:171], v25 offset:3456
ds_read_b128 v[172:175], v25 offset:3520
ds_read_b128 v[176:179], v25 offset:3584
ds_read_b128 v[180:183], v25 offset:3648
s_waitcnt lgkmcnt(13)
v_mfma_f32_16x16x32_bf16 v[28:31], v[64:67], v[128:131], 0
s_waitcnt lgkmcnt(12)
v_mfma_f32_16x16x32_bf16 v[28:31], v[68:71], v[132:135], v[28:31]
s_waitcnt lgkmcnt(11)
v_mfma_f32_16x16x32_bf16 v[28:31], v[72:75], v[136:139], v[28:31]
s_waitcnt lgkmcnt(10)
v_mfma_f32_16x16x32_bf16 v[28:31], v[76:79], v[140:143], v[28:31]
s_waitcnt lgkmcnt(9)
v_mfma_f32_16x16x32_bf16 v[28:31], v[80:83], v[144:147], v[28:31]
s_waitcnt lgkmcnt(8)
v_mfma_f32_16x16x32_bf16 v[28:31], v[84:87], v[148:151], v[28:31]
s_waitcnt lgkmcnt(7)
v_mfma_f32_16x16x32_bf16 v[28:31], v[88:91], v[152:155], v[28:31]
s_waitcnt lgkmcnt(6)
v_mfma_f32_16x16x32_bf16 v[28:31], v[92:95], v[156:159], v[28:31]
s_waitcnt lgkmcnt(5)
v_mfma_f32_16x16x32_bf16 v[28:31], v[96:99], v[160:163], v[28:31]
s_waitcnt lgkmcnt(4)
v_mfma_f32_16x16x32_bf16 v[28:31], v[100:103], v[164:167], v[28:31]
s_waitcnt lgkmcnt(3)
v_mfma_f32_16x16x32_bf16 v[28:31], v[104:107], v[168:171], v[28:31]
s_waitcnt lgkmcnt(2)
v_mfma_f32_16x16x32_bf16 v[28:31], v[108:111], v[172:175], v[28:31]
s_waitcnt lgkmcnt(1)
v_mfma_f32_16x16x32_bf16 v[28:31], v[112:115], v[176:179], v[28:31]
s_waitcnt lgkmcnt(0)
v_mfma_f32_16x16x32_bf16 v[28:31], v[116:119], v[180:183], v[28:31]
v_cmp_ne_u32 vcc, 0, v35
s_nop 6
v_cvt_pk_bf16_f32 v32, v28, v29
v_cvt_pk_bf16_f32 v33, v30, v31
s_mov_b32 exec_lo, 0x00030003
s_mov_b32 exec_hi, 0x00030003
s_cbranch_vccz L_sl_24
buffer_store_dwordx4 v[32:35], v46, s[8:11], s49 offen
s_branch L_sl_25
L_sl_24:
buffer_store_dwordx4 v[32:35], v46, s[8:11], s49 offen sc1
L_sl_25:
s_mov_b64 exec, 1
ds_add_u32 v2, v15 offset:264
s_mov_b64 exec, -1
s_branch L_w_ffn
L_ld_rest:
v_bfe_u32 v3, v0, 4, 1
v_lshlrev_b32 v3, 1, v3
v_and_b32 v4, 7, v0
v_xor_b32 v3, v3, v4
v_lshlrev_b32 v9, 4, v3
v_and_b32 v3, 32, v0
v_xor_b32 v10, v3, v1
v_xor_b32 v11, 64, v10
v_xor_b32 v12, 128, v10
v_xor_b32 v13, 192, v10
s_mov_b64 s[20:21], s[68:69]
s_mov_b32 s22, 134217728
s_mov_b32 s23, 0x20000
s_mov_b32 m0, 90112
s_mov_b32 s39, 6
s_mov_b32 s45, 0
s_cmp_eq_u32 s40, 0
s_cbranch_scc1 L_ld_v0
s_mov_b32 s14, 262144
L_wf_1:
ds_read_b32 v3, v2 offset:284
s_waitcnt lgkmcnt(0)
v_cmp_gt_i32 vcc, 4, v3
s_cbranch_vccz L_wd_2
s_sleep 1
s_sub_u32 s14, s14, 1
s_cbranch_scc0 L_wf_1
L_wd_2:
L_ld_v0:
L_ld_v:
buffer_load_dwordx4 v10, s[20:23], s37 offen offset:0 nt lds
s_waitcnt vmcnt(27)
buffer_load_dwordx4 v11, s[20:23], s37 offen offset:1024 nt lds
s_waitcnt vmcnt(27)
buffer_load_dwordx4 v10, s[20:23], s37 offen offset:2048 nt lds
s_waitcnt vmcnt(27)
buffer_load_dwordx4 v11, s[20:23], s37 offen offset:3072 nt lds
s_addk_i32 m0, 4096
s_addk_i32 s37, 4096
v_add_u32 v8, 4, v8
s_waitcnt vmcnt(27)
ds_write_b32 v5, v8
buffer_load_dwordx4 v12, s[20:23], s37 offen offset:0 nt lds
s_waitcnt vmcnt(27)
buffer_load_dwordx4 v13, s[20:23], s37 offen offset:1024 nt lds
s_waitcnt vmcnt(27)
buffer_load_dwordx4 v12, s[20:23], s37 offen offset:2048 nt lds
s_waitcnt vmcnt(27)
buffer_load_dwordx4 v13, s[20:23], s37 offen offset:3072 nt lds
s_addk_i32 m0, 4096
s_addk_i32 s37, 4096
v_add_u32 v8, 4, v8
s_waitcnt vmcnt(27)
ds_write_b32 v5, v8
s_sub_u32 s39, s39, 1
s_cmp_lg_u32 s39, 0
s_cbranch_scc1 L_ld_v
s_mov_b32 s14, 262144
L_wf_3:
ds_read_b32 v3, v2 offset:280
s_waitcnt lgkmcnt(0)
v_cmp_gt_i32 vcc, 6, v3
s_cbranch_vccz L_wd_4
s_sleep 1
s_sub_u32 s14, s14, 1
s_cbranch_scc0 L_wf_3
L_wd_4:
s_mov_b32 m0, 0
s_lshr_b32 s39, s15, 3
s_sub_u32 s39, s39, 6
v_subrev_u32 v8, 2, v8
L_ld_v2:
buffer_load_dwordx4 v10, s[20:23], s37 offen offset:0 nt lds
s_waitcnt vmcnt(29)
buffer_load_dwordx4 v11, s[20:23], s37 offen offset:1024 nt lds
s_waitcnt vmcnt(29)
buffer_load_dwordx4 v10, s[20:23], s37 offen offset:2048 nt lds
s_waitcnt vmcnt(29)
buffer_load_dwordx4 v11, s[20:23], s37 offen offset:3072 nt lds
s_addk_i32 m0, 4096
s_addk_i32 s37, 4096
v_add_u32 v8, 4, v8
s_waitcnt vmcnt(29)
ds_write_b32 v5, v8
buffer_load_dwordx4 v12, s[20:23], s37 offen offset:0 nt lds
s_waitcnt vmcnt(29)
buffer_load_dwordx4 v13, s[20:23], s37 offen offset:1024 nt lds
s_waitcnt vmcnt(29)
buffer_load_dwordx4 v12, s[20:23], s37 offen offset:2048 nt lds
s_waitcnt vmcnt(29)
buffer_load_dwordx4 v13, s[20:23], s37 offen offset:3072 nt lds
s_addk_i32 m0, 4096
s_addk_i32 s37, 4096
v_add_u32 v8, 4, v8
s_waitcnt vmcnt(29)
ds_write_b32 v5, v8
s_sub_u32 s39, s39, 1
s_cmp_lg_u32 s39, 0
s_cbranch_scc1 L_ld_v2
L_ld_v1:
s_cmp_eq_u32 s6, 7
s_cbranch_scc1 L_ld_drain
s_cmp_eq_u32 s7, 3
s_cbranch_scc1 L_ld_drain
s_mov_b64 s[24:25], s[72:73]
s_mov_b32 s26, 3670016
s_mov_b32 s27, 0x20000
v_lshrrev_b32 v3, 3, v0
v_mul_u32_u24 v6, 896, v3
v_add_u32 v6, v6, v9
v_xor_b32 v7, 64, v6
s_lshl_b32 s36, s5, 1
s_add_u32 s36, s36, s7
s_sub_u32 s36, s36, 1
s_mul_i32 s36, s36, 229376
s_lshl_b32 s37, s6, 7
s_add_u32 s36, s36, s37
v_subrev_u32 v8, 14, v8
s_mov_b32 m0, 40960
s_mov_b32 s39, 16
L_ld_wo:
buffer_load_dwordx4 v6, s[24:27], s36 offen lds
s_add_u32 m0, m0, 1024
s_add_u32 s36, s36, 7168
s_waitcnt vmcnt(43)
buffer_load_dwordx4 v7, s[24:27], s36 offen lds
s_add_u32 m0, m0, 1024
s_add_u32 s36, s36, 7168
v_add_u32 v8, 2, v8
s_waitcnt vmcnt(43)
ds_write_b32 v5, v8
s_sub_u32 s39, s39, 1
s_cmp_lg_u32 s39, 0
s_cbranch_scc1 L_ld_wo
v_add_u32 v8, 3, v8
s_waitcnt vmcnt(40)
ds_write_b32 v5, v8
v_add_u32 v8, 8, v8
s_waitcnt vmcnt(32)
ds_write_b32 v5, v8
v_add_u32 v8, 32, v8
s_waitcnt vmcnt(0)
ds_write_b32 v5, v8
s_waitcnt lgkmcnt(0)
s_endpgm
L_ld_drain:
v_add_u32 v8, 5, v8
s_waitcnt vmcnt(24)
ds_write_b32 v5, v8
v_add_u32 v8, 8, v8
s_waitcnt vmcnt(16)
ds_write_b32 v5, v8
v_add_u32 v8, 8, v8
s_waitcnt vmcnt(8)
ds_write_b32 v5, v8
v_add_u32 v8, 8, v8
s_waitcnt vmcnt(0)
ds_write_b32 v5, v8
s_waitcnt lgkmcnt(0)
s_endpgm
L_ld_q:
s_barrier
s_brev_b32 s10, 4
s_mov_b32 s11, 0x20000
s_movk_i32 s15, 88
s_cmp_eq_u32 s7, 3
s_cselect_b32 s15, 80, s15
v_bfe_u32 v3, v0, 4, 1
v_lshlrev_b32 v3, 1, v3
v_and_b32 v4, 7, v0
v_xor_b32 v3, v3, v4
v_lshlrev_b32 v9, 4, v3
s_setprio 3
s_load_dword s12, s[8:9], 0
s_lshl_b32 s46, s5, 5
s_add_u32 s46, s46, s3
s_lshl_b32 s46, s46, 7
s_add_u32 s46, s46, 65536
s_waitcnt lgkmcnt(0)
s_add_u32 s38, s12, 2654435769
s_getreg_b32 s45, hwreg(HW_REG_XCC_ID, 0, 4)
s_andn2_b32 s38, s38, 15
s_or_b32 s38, s38, s45
v_mov_b32 v4, s38
v_lshlrev_b32 v3, 2, v0
s_mov_b32 exec_hi, 0
buffer_store_dword v4, v3, s[8:11], s46 offen sc1
s_mov_b64 exec, -1
s_add_u32 s12, s12, 2654435769
s_lshl_b32 s38, s5, 7
s_add_u32 s38, s38, 40960
s_mov_b32 s14, 262144
v_mov_b32 v15, 1
L_ld_c0:
s_load_dwordx8 s[88:95], s[8:9], s38 glc
s_waitcnt lgkmcnt(0)
s_xor_b32 s36, s88, s12
s_xor_b32 s37, s89, s12
s_or_b32 s36, s36, s37
s_xor_b32 s37, s90, s12
s_or_b32 s36, s36, s37
s_xor_b32 s37, s91, s12
s_or_b32 s36, s36, s37
s_xor_b32 s37, s92, s12
s_or_b32 s36, s36, s37
s_xor_b32 s37, s93, s12
s_or_b32 s36, s36, s37
s_xor_b32 s37, s94, s12
s_or_b32 s36, s36, s37
s_xor_b32 s37, s95, s12
s_or_b32 s36, s36, s37
s_cbranch_scc0 L_ld_c1
s_sub_u32 s14, s14, 1
s_cbranch_scc0 L_ld_c0
L_ld_c1:
ds_write_b32 v2, v15 offset:304
s_waitcnt lgkmcnt(0)
s_endpgm
L_w_b:
s_cmp_lg_u32 s4, 5
s_cbranch_scc1 L_w_b0
s_lshl_b32 s46, s3, 7
s_add_u32 s46, s46, s97
s_waitcnt lgkmcnt(0)
s_add_u32 s38, s12, 2654435769
s_getreg_b32 s45, hwreg(HW_REG_XCC_ID, 0, 4)
s_andn2_b32 s38, s38, 15
s_or_b32 s38, s38, s45
v_mov_b32 v4, s38
v_lshlrev_b32 v3, 2, v0
s_mov_b32 exec_hi, 0
buffer_store_dword v4, v3, s[8:11], s46 offen sc1
s_mov_b64 exec, -1
s_cmp_eq_u32 s40, 0
s_cbranch_scc1 L_w_b00
s_cmp_lg_u32 s6, 6
s_cbranch_scc1 L_w_b00
s_add_u32 s37, s12, 2654435769
v_mov_b32 v4, s37
v_lshlrev_b32 v3, 7, v0
s_lshl_b32 s36, s5, 2
s_add_u32 s36, s36, 40960
s_mov_b64 exec, 0xff
buffer_store_dword v4, v3, s[8:11], s36 offen sc1
s_mov_b64 exec, -1
L_w_b00:
L_w_b0:
s_waitcnt lgkmcnt(0)
s_add_u32 s12, s12, 2654435769
s_mul_i32 s99, s6, 3
s_add_u32 s99, s99, s7
s_sub_u32 s99, s99, 1
s_cmp_eq_u32 s4, 7
s_cbranch_scc1 L_w_ctl
v_lshlrev_b32 v3, 10, v16
s_lshl_b32 s36, s13, 14
v_add_u32 v5, s36, v3
v_add_u32 v4, 0, v17
v_xor_b32 v4, v4, v16
v_lshl_add_u32 v6, v4, 4, v5
v_add_u32 v4, 4, v17
v_xor_b32 v4, v4, v16
v_lshl_add_u32 v7, v4, 4, v5
v_add_u32 v4, 8, v17
v_xor_b32 v4, v4, v16
v_lshl_add_u32 v8, v4, 4, v5
v_add_u32 v4, 12, v17
v_xor_b32 v4, v4, v16
v_lshl_add_u32 v9, v4, 4, v5
v_and_b32 v3, 1, v0
v_lshl_add_u32 v18, v3, 9, v25
v_lshlrev_b32 v27, 10, v3
v_lshrrev_b32 v10, 1, v16
v_lshl_add_u32 v27, v10, 6, v27
v_lshl_add_u32 v27, v17, 4, v27
v_mul_u32_u24 v3, 384, v3
v_add_u32 v176, v3, v25
v_and_b32 v19, 1, v17
s_lshl_b32 s36, s13, 3
v_lshl_add_u32 v24, v19, 2, v2
v_add_u32 v26, s36, v24
s_lshl_b32 s36, s13, 6
v_lshl_add_u32 v3, v16, 2, v2
v_mul_u32_u24 v4, 384, v19
v_add3_u32 v44, v3, s36, v4
s_lshl_b32 s36, s13, 4
v_add_u32 v46, s36, v16
v_mov_b32 v45, 0xff7f0000
v_lshrrev_b32 v3, 2, v16
v_lshl_add_u32 v4, v17, 3, v3
v_lshlrev_b32 v188, 9, v4
v_bfe_u32 v4, v0, 2, 3
s_and_b32 s36, s13, 1
s_lshl_b32 s36, s36, 2
v_xor_b32 v4, s36, v4
v_lshl_add_u32 v188, v4, 5, v188
v_and_b32 v4, 3, v0
v_lshl_add_u32 v188, v4, 3, v188
s_lshr_b32 s36, s13, 1
s_lshl_b32 s36, s36, 8
v_add_u32 v188, s36, v188
v_add_u32 v184, 90112, v188
s_cmp_eq_u32 s7, 3
s_cselect_b32 s36, 0, 8192
v_lshrrev_b32 v3, 5, v0
v_mul_u32_u24 v3, s36, v3
v_sub_u32 v192, v188, v3
s_lshl_b32 s36, s36, 1
s_add_u32 s36, s36, 16384
v_add_u32 v192, s36, v192
v_xor_b32 v185, 32, v184
v_xor_b32 v189, 32, v188
v_xor_b32 v193, 32, v192
v_xor_b32 v186, 64, v184
v_xor_b32 v190, 64, v188
v_xor_b32 v194, 64, v192
v_xor_b32 v187, 96, v184
v_xor_b32 v191, 96, v188
v_xor_b32 v195, 96, v192
s_lshr_b32 s36, s36, 8
s_add_u32 s36, s36, 192
v_add_u32 v177, s36, v176
s_lshl_b32 s36, s13, 13
s_add_u32 s36, s36, 40960
v_add_u32 v200, s36, v14
v_xor_b32 v201, 32, v200
v_xor_b32 v202, 64, v200
v_xor_b32 v203, 96, v200
v_lshlrev_b32 v204, 11, v17
v_lshl_add_u32 v204, v16, 4, v204
s_lshl_b32 s36, s13, 7
s_add_u32 s36, s36, 6656
v_lshl_add_u32 v3, v16, 2, v17
v_lshl_add_u32 v3, v3, 1, v2
v_add_u32 v205, s36, v3
v_add_u32 v5, s36, v25
v_mov_b32 v4, 147968
v_cmp_eq_u32 vcc, 0, v16
s_nop 1
v_cndmask_b32 v206, v4, v5, vcc
v_cmp_eq_u32 vcc, 1, v16
s_nop 1
v_cndmask_b32 v207, v4, v5, vcc
v_cmp_eq_u32 vcc, 2, v16
s_nop 1
v_cndmask_b32 v208, v4, v5, vcc
v_cmp_eq_u32 vcc, 3, v16
s_nop 1
v_cndmask_b32 v209, v4, v5, vcc
s_lshl_b32 s36, s13, 8
v_lshl_add_u32 v3, v16, 6, v25
v_add_u32 v210, s36, v3
v_lshl_add_u32 v211, v17, 5, v2
v_and_b32 v4, 3, v0
v_bfe_u32 v3, v0, 2, 3
v_lshl_add_u32 v3, v4, 3, v3
v_lshl_add_u32 v214, v3, 2, v2
v_lshl_add_u32 v212, v16, 4, v2
v_mul_u32_u24 v213, 28672, v17
v_lshl_add_u32 v213, v16, 4, v213
s_lshl_b32 s36, s4, 4
s_min_u32 s36, s36, s15
s_mov_b32 s14, 262144
L_wf_26:
ds_read_b32 v3, v2 offset:0
s_waitcnt lgkmcnt(0)
v_cmp_gt_i32 vcc, s36, v3
s_cbranch_vccz L_wd_27
s_sleep 1
s_sub_u32 s14, s14, 1
s_cbranch_scc0 L_wf_26
L_wd_27:
ds_read_b128 v[64:67], v6 offset:0
ds_read_b128 v[68:71], v7 offset:0
ds_read_b128 v[72:75], v8 offset:0
ds_read_b128 v[76:79], v9 offset:0
ds_read_b128 v[80:83], v6 offset:256
ds_read_b128 v[84:87], v7 offset:256
ds_read_b128 v[88:91], v8 offset:256
ds_read_b128 v[92:95], v9 offset:256
ds_read_b128 v[96:99], v6 offset:512
ds_read_b128 v[100:103], v7 offset:512
ds_read_b128 v[104:107], v8 offset:512
ds_read_b128 v[108:111], v9 offset:512
ds_read_b128 v[112:115], v6 offset:768
ds_read_b128 v[116:119], v7 offset:768
ds_read_b128 v[120:123], v8 offset:768
ds_read_b128 v[124:127], v9 offset:768
s_mov_b64 exec, 1
ds_add_u32 v2, v15 offset:280
s_mov_b64 exec, -1
v_lshrrev_b32 v3, 1, v16
v_cmp_eq_u32 s[76:77], 1, v3
v_cmp_eq_u32 s[78:79], 3, v3
v_cmp_lt_u32 s[80:81], 1, v3
s_add_u32 s47, s97, 32768
s_cmp_eq_u32 s7, 2
s_cselect_b64 s[48:49], -1, 0
s_lshl_b32 s43, s5, 16
s_lshl_b32 s36, s99, 11
s_add_u32 s43, s43, s36
s_lshl_b32 s36, s13, 8
s_add_u32 s43, s43, s36
s_add_u32 s43, s43, 262144
v_cmp_eq_u32 s[50:51], 1, v19
v_cmp_gt_u32 s[52:53], s15, v46
s_lshl_b32 s54, s5, 16
s_lshl_b32 s36, s7, 10
s_add_u32 s54, s54, s36
s_lshl_b32 s36, s13, 8
s_add_u32 s54, s54, s36
s_add_u32 s54, s54, 261120
s_add_u32 s55, s54, 8192
s_add_u32 s56, s54, 16384
s_add_u32 s57, s54, 24576
s_add_u32 s58, s54, 32768
s_add_u32 s59, s54, 40960
s_lshl_b32 s45, s5, 1
s_add_u32 s45, s45, s7
s_mul_i32 s45, s45, 1792
s_lshl_b32 s37, s6, 8
s_add_u32 s45, s45, s37
s_add_u32 s45, s45, 981248
s_add_u32 s46, s45, 114688
s_mov_b32 s14, 262144
L_wf_28:
ds_read_b32 v3, v2 offset:268
s_waitcnt lgkmcnt(0)
v_cmp_gt_i32 vcc, 1, v3
s_cbranch_vccz L_wd_29
s_sub_u32 s14, s14, 1
s_cbranch_scc0 L_wf_28
L_wd_29:
v_readfirstlane_b32 s98, v3
s_setprio 2
ds_read_b32 v10, v2 offset:0
ds_read_b128 v[128:131], v18 offset:1024
ds_read_b128 v[132:135], v18 offset:1088
ds_read_b128 v[136:139], v18 offset:1152
ds_read_b128 v[140:143], v18 offset:1216
ds_read_b128 v[144:147], v18 offset:1280
ds_read_b128 v[148:151], v18 offset:1344
ds_read_b128 v[152:155], v18 offset:1408
ds_read_b128 v[156:159], v18 offset:1472
s_waitcnt lgkmcnt(7)
v_mfma_f32_16x16x32_bf16 v[28:31], v[128:131], v[64:67], 0
v_mfma_f32_16x16x32_bf16 v[32:35], v[128:131], v[96:99], 0
s_waitcnt lgkmcnt(6)
v_mfma_f32_16x16x32_bf16 v[28:31], v[132:135], v[68:71], v[28:31]
v_mfma_f32_16x16x32_bf16 v[32:35], v[132:135], v[100:103], v[32:35]
s_waitcnt lgkmcnt(5)
v_mfma_f32_16x16x32_bf16 v[28:31], v[136:139], v[72:75], v[28:31]
v_mfma_f32_16x16x32_bf16 v[32:35], v[136:139], v[104:107], v[32:35]
s_waitcnt lgkmcnt(4)
v_mfma_f32_16x16x32_bf16 v[28:31], v[140:143], v[76:79], v[28:31]
v_mfma_f32_16x16x32_bf16 v[32:35], v[140:143], v[108:111], v[32:35]
s_waitcnt lgkmcnt(3)
v_mfma_f32_16x16x32_bf16 v[28:31], v[144:147], v[80:83], v[28:31]
v_mfma_f32_16x16x32_bf16 v[32:35], v[144:147], v[112:115], v[32:35]
s_waitcnt lgkmcnt(2)
v_mfma_f32_16x16x32_bf16 v[28:31], v[148:151], v[84:87], v[28:31]
v_mfma_f32_16x16x32_bf16 v[32:35], v[148:151], v[116:119], v[32:35]
s_waitcnt lgkmcnt(1)
v_mfma_f32_16x16x32_bf16 v[28:31], v[152:155], v[88:91], v[28:31]
v_mfma_f32_16x16x32_bf16 v[32:35], v[152:155], v[120:123], v[32:35]
s_waitcnt lgkmcnt(0)
v_mfma_f32_16x16x32_bf16 v[28:31], v[156:159], v[92:95], v[28:31]
v_mfma_f32_16x16x32_bf16 v[32:35], v[156:159], v[124:127], v[32:35]
v_readfirstlane_b32 s44, v10
s_add_u32 s41, s15, 48
s_cmp_gt_u32 s4, 4
s_cselect_b32 s44, 0, s44
s_nop 2
v_cndmask_b32 v28, v28, v29, s[50:51]
v_cndmask_b32 v32, v32, v33, s[50:51]
v_cvt_pk_bf16_f32 v28, 0, v28
v_cvt_pk_bf16_f32 v32, 0, v32
v_cndmask_b32 v28, v45, v28, s[52:53]
v_cndmask_b32 v32, v45, v32, s[52:53]
v_max_f32 v4, v28, v32
s_nop 1
v_max_f32_dpp v4, v4, v4 row_ror:1 row_mask:0xf bank_mask:0xf
s_nop 1
v_max_f32_dpp v4, v4, v4 row_ror:2 row_mask:0xf bank_mask:0xf
s_nop 1
v_max_f32_dpp v4, v4, v4 row_ror:4 row_mask:0xf bank_mask:0xf
s_nop 1
v_max_f32_dpp v4, v4, v4 row_ror:8 row_mask:0xf bank_mask:0xf
v_or_b32 v4, 1, v4
s_mov_b64 exec, 0x00010001
ds_write_b32 v26, v4 offset:320
s_mov_b64 exec, -1
s_mov_b32 s14, 262144
L_pl_30:
ds_read2_b32 v[4:5], v24 offset0:80 offset1:82
ds_read2_b32 v[6:7], v24 offset0:84 offset1:86
ds_read2_b32 v[8:9], v24 offset0:88 offset1:90
s_waitcnt lgkmcnt(0)
v_and_b32 v3, v4, v5
v_and_b32 v10, v6, v7
v_max3_f32 v4, v4, v5, v6
v_and_b32 v11, v8, v9
v_max3_f32 v7, v7, v8, v9
v_and_b32 v3, v3, v10
v_and_b32 v11, 1, v11
v_max_f32 v49, v4, v7
v_and_b32 v3, v3, v11
v_cmp_eq_u32 vcc, 0, v3
v_and_b32 v49, 0xffff0000, v49
s_cbranch_vccz L_pd_31
s_sub_u32 s14, s14, 1
s_cbranch_scc0 L_pl_30
L_pd_31:
v_sub_f32 v28, v28, v49
v_sub_f32 v32, v32, v49
v_mul_f32 v28, 1035512379, v28
v_mul_f32 v32, 1035512379, v32
v_exp_f32 v28, v28
v_exp_f32 v32, v32
s_nop 0
v_add_f32 v5, v28, v32
v_cvt_pk_bf16_f32 v28, v28, v32
s_mov_b32 exec_hi, 0
ds_write_b32 v44, v28 offset:2048
s_mov_b64 exec, 1
ds_add_u32 v2, v15 offset:276
s_mov_b64 exec, -1
v_add_f32_dpp v5, v5, v5 row_ror:1 row_mask:0xf bank_mask:0xf
s_nop 1
v_add_f32_dpp v5, v5, v5 row_ror:2 row_mask:0xf bank_mask:0xf
s_nop 1
v_add_f32_dpp v5, v5, v5 row_ror:4 row_mask:0xf bank_mask:0xf
s_nop 1
v_add_f32_dpp v5, v5, v5 row_ror:8 row_mask:0xf bank_mask:0xf
s_mov_b64 exec, 0x00010001
ds_write_b32 v26, v5 offset:368
s_mov_b64 exec, 1
ds_add_u32 v2, v15 offset:272
s_mov_b64 exec, -1
s_cmp_eq_u32 s4, 5
s_cbranch_scc1 L_w_sp
s_cmp_eq_u32 s4, 6
s_cbranch_scc1 L_w_gu
s_cmp_ge_i32 s44, s41
s_cbranch_scc1 L_w_pv0
s_mov_b32 s14, 262144
L_wf_32:
ds_read_b32 v3, v2 offset:0
s_waitcnt lgkmcnt(0)
v_cmp_gt_i32 vcc, s41, v3
s_cbranch_vccz L_wd_33
s_sleep 1
s_sub_u32 s14, s14, 1
s_cbranch_scc0 L_wf_32
L_wd_33:
L_w_pv0:
ds_read_b64_tr_b16 v[128:129], v184 offset:0
ds_read_b64_tr_b16 v[130:131], v184 offset:2048
ds_read_b64_tr_b16 v[132:133], v185 offset:0
ds_read_b64_tr_b16 v[134:135], v185 offset:2048
ds_read_b64_tr_b16 v[136:137], v186 offset:0
ds_read_b64_tr_b16 v[138:139], v186 offset:2048
ds_read_b64_tr_b16 v[140:141], v187 offset:0
ds_read_b64_tr_b16 v[142:143], v187 offset:2048
ds_read_b64_tr_b16 v[144:145], v184 offset:16384
ds_read_b64_tr_b16 v[146:147], v184 offset:18432
ds_read_b64_tr_b16 v[148:149], v185 offset:16384
ds_read_b64_tr_b16 v[150:151], v185 offset:18432
ds_read_b64_tr_b16 v[152:153], v186 offset:16384
ds_read_b64_tr_b16 v[154:155], v186 offset:18432
ds_read_b64_tr_b16 v[156:157], v187 offset:16384
ds_read_b64_tr_b16 v[158:159], v187 offset:18432
ds_read_b64_tr_b16 v[112:113], v184 offset:32768
ds_read_b64_tr_b16 v[114:115], v184 offset:34816
ds_read_b64_tr_b16 v[116:117], v185 offset:32768
ds_read_b64_tr_b16 v[118:119], v185 offset:34816
ds_read_b64_tr_b16 v[120:121], v186 offset:32768
ds_read_b64_tr_b16 v[122:123], v186 offset:34816
ds_read_b64_tr_b16 v[124:125], v187 offset:32768
ds_read_b64_tr_b16 v[126:127], v187 offset:34816
s_mov_b32 s14, 262144
L_wf_34:
ds_read_b32 v3, v2 offset:276
s_waitcnt lgkmcnt(0)
v_cmp_gt_i32 vcc, 6, v3
s_cbranch_vccz L_wd_35
s_sub_u32 s14, s14, 1
s_cbranch_scc0 L_wf_34
L_wd_35:
ds_read_b32 v3, v2 offset:0
ds_read_b128 v[64:67], v176 offset:2048
ds_read_b128 v[68:71], v176 offset:2112
ds_read_b128 v[72:75], v176 offset:2176
ds_read_b128 v[76:79], v176 offset:2240
ds_read_b128 v[80:83], v176 offset:2304
ds_read_b128 v[84:87], v177 offset:2048
s_waitcnt lgkmcnt(6)
v_readfirstlane_b32 s44, v3
s_waitcnt lgkmcnt(5)
v_mfma_f32_16x16x32_bf16 v[96:99], v[128:131], v[64:67], 0
v_mfma_f32_16x16x32_bf16 v[100:103], v[132:135], v[64:67], 0
v_mfma_f32_16x16x32_bf16 v[104:107], v[136:139], v[64:67], 0
v_mfma_f32_16x16x32_bf16 v[108:111], v[140:143], v[64:67], 0
s_waitcnt lgkmcnt(0)
s_add_u32 s36, s15, 64
s_cmp_ge_i32 s44, s36
s_cbranch_scc1 L_pv_36
s_mov_b32 s14, 262144
L_wf_37:
ds_read_b32 v3, v2 offset:0
s_waitcnt lgkmcnt(0)
v_cmp_gt_i32 vcc, s36, v3
s_cbranch_vccz L_wd_38
s_sleep 1
s_sub_u32 s14, s14, 1
s_cbranch_scc0 L_wf_37
L_wd_38:
v_readfirstlane_b32 s44, v3
L_pv_36:
ds_read_b64_tr_b16 v[160:161], v188 offset:0
ds_read_b64_tr_b16 v[162:163], v188 offset:2048
ds_read_b64_tr_b16 v[164:165], v189 offset:0
ds_read_b64_tr_b16 v[166:167], v189 offset:2048
ds_read_b64_tr_b16 v[168:169], v190 offset:0
ds_read_b64_tr_b16 v[170:171], v190 offset:2048
ds_read_b64_tr_b16 v[172:173], v191 offset:0
ds_read_b64_tr_b16 v[174:175], v191 offset:2048
v_mfma_f32_16x16x32_bf16 v[96:99], v[144:147], v[68:71], v[96:99]
v_mfma_f32_16x16x32_bf16 v[100:103], v[148:151], v[68:71], v[100:103]
v_mfma_f32_16x16x32_bf16 v[104:107], v[152:155], v[68:71], v[104:107]
v_mfma_f32_16x16x32_bf16 v[108:111], v[156:159], v[68:71], v[108:111]
v_mfma_f32_16x16x32_bf16 v[96:99], v[112:115], v[72:75], v[96:99]
v_mfma_f32_16x16x32_bf16 v[100:103], v[116:119], v[72:75], v[100:103]
v_mfma_f32_16x16x32_bf16 v[104:107], v[120:123], v[72:75], v[104:107]
v_mfma_f32_16x16x32_bf16 v[108:111], v[124:127], v[72:75], v[108:111]
s_cmp_eq_u32 s7, 3
s_cbranch_scc1 L_w_pv3
s_add_u32 s36, s15, 80
s_cmp_ge_i32 s44, s36
s_cbranch_scc1 L_pv_39
s_mov_b32 s14, 262144
L_wf_40:
ds_read_b32 v3, v2 offset:0
s_waitcnt lgkmcnt(0)
v_cmp_gt_i32 vcc, s36, v3
s_cbranch_vccz L_wd_41
s_sleep 1
s_sub_u32 s14, s14, 1
s_cbranch_scc0 L_wf_40
L_wd_41:
v_readfirstlane_b32 s44, v3
L_pv_39:
ds_read_b64_tr_b16 v[128:129], v188 offset:16384
ds_read_b64_tr_b16 v[130:131], v188 offset:18432
ds_read_b64_tr_b16 v[132:133], v189 offset:16384
ds_read_b64_tr_b16 v[134:135], v189 offset:18432
ds_read_b64_tr_b16 v[136:137], v190 offset:16384
ds_read_b64_tr_b16 v[138:139], v190 offset:18432
ds_read_b64_tr_b16 v[140:141], v191 offset:16384
ds_read_b64_tr_b16 v[142:143], v191 offset:18432
s_waitcnt lgkmcnt(14)
v_mfma_f32_16x16x32_bf16 v[96:99], v[160:163], v[76:79], v[96:99]
s_waitcnt lgkmcnt(12)
v_mfma_f32_16x16x32_bf16 v[100:103], v[164:167], v[76:79], v[100:103]
s_waitcnt lgkmcnt(10)
v_mfma_f32_16x16x32_bf16 v[104:107], v[168:171], v[76:79], v[104:107]
s_waitcnt lgkmcnt(8)
v_mfma_f32_16x16x32_bf16 v[108:111], v[172:175], v[76:79], v[108:111]
s_waitcnt lgkmcnt(6)
v_mfma_f32_16x16x32_bf16 v[96:99], v[128:131], v[80:83], v[96:99]
s_waitcnt lgkmcnt(4)
v_mfma_f32_16x16x32_bf16 v[100:103], v[132:135], v[80:83], v[100:103]
s_waitcnt lgkmcnt(2)
v_mfma_f32_16x16x32_bf16 v[104:107], v[136:139], v[80:83], v[104:107]
s_waitcnt lgkmcnt(0)
v_mfma_f32_16x16x32_bf16 v[108:111], v[140:143], v[80:83], v[108:111]
s_branch L_w_pvs
L_w_pv3:
s_waitcnt lgkmcnt(6)
v_mfma_f32_16x16x32_bf16 v[96:99], v[160:163], v[76:79], v[96:99]
s_waitcnt lgkmcnt(4)
v_mfma_f32_16x16x32_bf16 v[100:103], v[164:167], v[76:79], v[100:103]
s_waitcnt lgkmcnt(2)
v_mfma_f32_16x16x32_bf16 v[104:107], v[168:171], v[76:79], v[104:107]
s_waitcnt lgkmcnt(0)
v_mfma_f32_16x16x32_bf16 v[108:111], v[172:175], v[76:79], v[108:111]
L_w_pvs:
s_lshl_b32 s36, s15, 1
s_mov_b32 s14, 262144
L_wf_42:
ds_read_b32 v3, v2 offset:0
s_waitcnt lgkmcnt(0)
v_cmp_gt_i32 vcc, s36, v3
s_cbranch_vccz L_wd_43
s_sub_u32 s14, s14, 1
s_cbranch_scc0 L_wf_42
L_wd_43:
ds_read_b64_tr_b16 v[144:145], v192 offset:0
ds_read_b64_tr_b16 v[146:147], v192 offset:2048
ds_read_b64_tr_b16 v[148:149], v193 offset:0
ds_read_b64_tr_b16 v[150:151], v193 offset:2048
ds_read_b64_tr_b16 v[152:153], v194 offset:0
ds_read_b64_tr_b16 v[154:155], v194 offset:2048
ds_read_b64_tr_b16 v[156:157], v195 offset:0
ds_read_b64_tr_b16 v[158:159], v195 offset:2048
s_cmp_eq_u32 s98, 2
s_cselect_b64 vcc, -1, 0
s_waitcnt lgkmcnt(6)
v_mfma_f32_16x16x32_bf16 v[96:99], v[144:147], v[84:87], v[96:99]
s_waitcnt lgkmcnt(4)
v_mfma_f32_16x16x32_bf16 v[100:103], v[148:151], v[84:87], v[100:103]
s_waitcnt lgkmcnt(2)
v_mfma_f32_16x16x32_bf16 v[104:107], v[152:155], v[84:87], v[104:107]
s_waitcnt lgkmcnt(0)
v_mfma_f32_16x16x32_bf16 v[108:111], v[156:159], v[84:87], v[108:111]
s_nop 3
v_cndmask_b32 v28, v96, v100, s[76:77]
v_cndmask_b32 v29, v97, v101, s[76:77]
v_cndmask_b32 v30, v98, v102, s[76:77]
v_cndmask_b32 v31, v99, v103, s[76:77]
v_cndmask_b32 v32, v104, v108, s[78:79]
v_cndmask_b32 v33, v105, v109, s[78:79]
v_cndmask_b32 v34, v106, v110, s[78:79]
v_cndmask_b32 v35, v107, v111, s[78:79]
v_cndmask_b32 v28, v28, v32, s[80:81]
v_cndmask_b32 v29, v29, v33, s[80:81]
v_cndmask_b32 v30, v30, v34, s[80:81]
v_cndmask_b32 v31, v31, v35, s[80:81]
s_mov_b32 exec_lo, 0x00ff00ff
s_mov_b32 exec_hi, 0x00ff00ff
s_cbranch_vccz L_sl_44
buffer_store_dwordx4 v[28:31], v27, s[8:11], s43 offen
s_branch L_sl_45
L_sl_44:
buffer_store_dwordx4 v[28:31], v27, s[8:11], s43 offen sc1
L_sl_45:
s_mov_b64 exec, -1
s_cmp_eq_u32 s6, 7
s_cbranch_scc1 L_w_end
s_cmp_eq_u32 s7, 3
s_cbranch_scc1 L_w_end
buffer_load_dwordx4 v[128:131], v204, s[8:11], s54 offen sc1
buffer_load_dwordx4 v[132:135], v204, s[8:11], s55 offen sc1
buffer_load_dwordx4 v[136:139], v204, s[8:11], s56 offen sc1
buffer_load_dwordx4 v[140:143], v204, s[8:11], s57 offen sc1
buffer_load_dwordx4 v[144:147], v204, s[8:11], s58 offen sc1
buffer_load_dwordx4 v[148:151], v204, s[8:11], s59 offen sc1
s_mov_b32 s14, 262144
L_wf_49:
ds_read_b32 v3, v2 offset:0
s_waitcnt lgkmcnt(0)
v_cmp_gt_i32 vcc, 208, v3
s_cbranch_vccz L_wd_50
s_sub_u32 s14, s14, 1
s_cbranch_scc0 L_wf_49
L_wd_50:
ds_read_b64_tr_b16 v[64:65], v200 offset:0
ds_read_b64_tr_b16 v[66:67], v200 offset:512
ds_read_b64_tr_b16 v[68:69], v200 offset:4096
ds_read_b64_tr_b16 v[70:71], v200 offset:4608
ds_read_b64_tr_b16 v[72:73], v201 offset:0
ds_read_b64_tr_b16 v[74:75], v201 offset:512
ds_read_b64_tr_b16 v[76:77], v201 offset:4096
ds_read_b64_tr_b16 v[78:79], v201 offset:4608
ds_read_b64_tr_b16 v[80:81], v202 offset:0
ds_read_b64_tr_b16 v[82:83], v202 offset:512
ds_read_b64_tr_b16 v[84:85], v202 offset:4096
ds_read_b64_tr_b16 v[86:87], v202 offset:4608
ds_read_b64_tr_b16 v[88:89], v203 offset:0
ds_read_b64_tr_b16 v[90:91], v203 offset:512
ds_read_b64_tr_b16 v[92:93], v203 offset:4096
ds_read_b64_tr_b16 v[94:95], v203 offset:4608
s_mov_b32 s14, 262144
L_wf_51:
ds_read_b32 v3, v2 offset:300
s_waitcnt lgkmcnt(0)
v_cmp_gt_i32 vcc, 1, v3
s_cbranch_vccz L_wd_52
s_sub_u32 s14, s14, 1
s_cbranch_scc0 L_wf_51
L_wd_52:
ds_read_b128 v[56:59], v211 offset:8320
ds_read_b64 v[60:61], v211 offset:8336
s_mov_b32 s14, 262144
s_waitcnt vmcnt(5)
v_cmp_eq_u32 vcc, v20, v128
s_nop 0
s_mov_b64 s[60:61], vcc
s_mov_b64 s[36:37], vcc
s_waitcnt vmcnt(4)
v_cmp_eq_u32 vcc, v20, v132
s_nop 0
s_mov_b64 s[62:63], vcc
s_or_b64 s[36:37], s[36:37], vcc
s_waitcnt vmcnt(3)
v_cmp_eq_u32 vcc, v20, v136
s_nop 0
s_mov_b64 s[64:65], vcc
s_or_b64 s[36:37], s[36:37], vcc
s_waitcnt vmcnt(2)
v_cmp_eq_u32 vcc, v20, v140
s_nop 0
s_mov_b64 s[66:67], vcc
s_or_b64 s[36:37], s[36:37], vcc
s_waitcnt vmcnt(1)
v_cmp_eq_u32 vcc, v20, v144
s_nop 0
s_mov_b64 s[68:69], vcc
s_or_b64 s[36:37], s[36:37], vcc
s_waitcnt vmcnt(0)
v_cmp_eq_u32 vcc, v20, v148
s_nop 0
s_mov_b64 s[70:71], vcc
s_or_b64 s[36:37], s[36:37], vcc
s_cmp_eq_u64 s[36:37], 0
s_cbranch_scc1 L_gd_48
L_g_46:
s_mov_b64 exec, s[60:61]
s_cbranch_execz L_gs_53
buffer_load_dwordx4 v[128:131], v204, s[8:11], s54 offen sc1
L_gs_53:
s_mov_b64 exec, s[62:63]
s_cbranch_execz L_gs_54
buffer_load_dwordx4 v[132:135], v204, s[8:11], s55 offen sc1
L_gs_54:
s_mov_b64 exec, s[64:65]
s_cbranch_execz L_gs_55
buffer_load_dwordx4 v[136:139], v204, s[8:11], s56 offen sc1
L_gs_55:
s_mov_b64 exec, s[66:67]
s_cbranch_execz L_gs_56
buffer_load_dwordx4 v[140:143], v204, s[8:11], s57 offen sc1
L_gs_56:
s_mov_b64 exec, s[68:69]
s_cbranch_execz L_gs_57
buffer_load_dwordx4 v[144:147], v204, s[8:11], s58 offen sc1
L_gs_57:
s_mov_b64 exec, s[70:71]
s_cbranch_execz L_gs_58
buffer_load_dwordx4 v[148:151], v204, s[8:11], s59 offen sc1
L_gs_58:
s_mov_b64 s[36:37], 0
s_waitcnt vmcnt(0)
s_mov_b64 exec, s[60:61]
s_cbranch_execz L_gs_59
v_cmp_eq_u32 vcc, v20, v128
s_nop 0
s_mov_b64 s[60:61], vcc
s_or_b64 s[36:37], s[36:37], vcc
L_gs_59:
s_mov_b64 exec, s[62:63]
s_cbranch_execz L_gs_60
v_cmp_eq_u32 vcc, v20, v132
s_nop 0
s_mov_b64 s[62:63], vcc
s_or_b64 s[36:37], s[36:37], vcc
L_gs_60:
s_mov_b64 exec, s[64:65]
s_cbranch_execz L_gs_61
v_cmp_eq_u32 vcc, v20, v136
s_nop 0
s_mov_b64 s[64:65], vcc
s_or_b64 s[36:37], s[36:37], vcc
L_gs_61:
s_mov_b64 exec, s[66:67]
s_cbranch_execz L_gs_62
v_cmp_eq_u32 vcc, v20, v140
s_nop 0
s_mov_b64 s[66:67], vcc
s_or_b64 s[36:37], s[36:37], vcc
L_gs_62:
s_mov_b64 exec, s[68:69]
s_cbranch_execz L_gs_63
v_cmp_eq_u32 vcc, v20, v144
s_nop 0
s_mov_b64 s[68:69], vcc
s_or_b64 s[36:37], s[36:37], vcc
L_gs_63:
s_mov_b64 exec, s[70:71]
s_cbranch_execz L_gs_64
v_cmp_eq_u32 vcc, v20, v148
s_nop 0
s_mov_b64 s[70:71], vcc
s_or_b64 s[36:37], s[36:37], vcc
L_gs_64:
s_mov_b64 exec, -1
s_cmp_eq_u64 s[36:37], 0
s_cbranch_scc1 L_gd_48
s_sub_u32 s14, s14, 1
s_cbranch_scc0 L_g_46
L_gd_48:
s_waitcnt lgkmcnt(0)
v_pk_mul_f32 v[36:37], v[56:57], v[128:129] op_sel:[0,0] op_sel_hi:[0,1]
v_pk_mul_f32 v[38:39], v[56:57], v[130:131] op_sel:[0,0] op_sel_hi:[0,1]
v_pk_mul_f32 v[40:41], v[56:57], v[132:133] op_sel:[1,0] op_sel_hi:[1,1]
v_pk_mul_f32 v[42:43], v[56:57], v[134:135] op_sel:[1,0] op_sel_hi:[1,1]
v_pk_fma_f32 v[36:37], v[58:59], v[136:137], v[36:37] op_sel:[0,0,0] op_sel_hi:[0,1,1]
v_pk_fma_f32 v[38:39], v[58:59], v[138:139], v[38:39] op_sel:[0,0,0] op_sel_hi:[0,1,1]
v_pk_fma_f32 v[40:41], v[58:59], v[140:141], v[40:41] op_sel:[1,0,0] op_sel_hi:[1,1,1]
v_pk_fma_f32 v[42:43], v[58:59], v[142:143], v[42:43] op_sel:[1,0,0] op_sel_hi:[1,1,1]
v_pk_fma_f32 v[36:37], v[60:61], v[144:145], v[36:37] op_sel:[0,0,0] op_sel_hi:[0,1,1]
v_pk_fma_f32 v[38:39], v[60:61], v[146:147], v[38:39] op_sel:[0,0,0] op_sel_hi:[0,1,1]
v_pk_fma_f32 v[40:41], v[60:61], v[148:149], v[40:41] op_sel:[1,0,0] op_sel_hi:[1,1,1]
v_pk_fma_f32 v[42:43], v[60:61], v[150:151], v[42:43] op_sel:[1,0,0] op_sel_hi:[1,1,1]
v_pk_add_f32 v[36:37], v[36:37], v[40:41]
v_pk_add_f32 v[38:39], v[38:39], v[42:43]
s_nop 1
v_permlane32_swap_b32 v36, v38
v_permlane32_swap_b32 v37, v39
v_add_f32 v36, v36, v38
v_add_f32 v37, v37, v39
s_nop 1
v_permlane16_swap_b32 v36, v37
v_add_f32 v36, v36, v37
v_cvt_pk_bf16_f32 v36, v36, v36
ds_write_b16 v205, v36
ds_read_b128 v[128:131], v206 offset:0
ds_read_b128 v[132:135], v206 offset:64
ds_read_b128 v[136:139], v207 offset:0
ds_read_b128 v[140:143], v207 offset:64
ds_read_b128 v[144:147], v208 offset:0
ds_read_b128 v[148:151], v208 offset:64
ds_read_b128 v[152:155], v209 offset:0
ds_read_b128 v[156:159], v209 offset:64
s_waitcnt lgkmcnt(7)
v_mfma_f32_16x16x32_bf16 v[28:31], v[64:67], v[128:131], 0
s_waitcnt lgkmcnt(6)
v_mfma_f32_16x16x32_bf16 v[28:31], v[68:71], v[132:135], v[28:31]
s_waitcnt lgkmcnt(5)
v_mfma_f32_16x16x32_bf16 v[28:31], v[72:75], v[136:139], v[28:31]
s_waitcnt lgkmcnt(4)
v_mfma_f32_16x16x32_bf16 v[28:31], v[76:79], v[140:143], v[28:31]
s_waitcnt lgkmcnt(3)
v_mfma_f32_16x16x32_bf16 v[28:31], v[80:83], v[144:147], v[28:31]
s_waitcnt lgkmcnt(2)
v_mfma_f32_16x16x32_bf16 v[28:31], v[84:87], v[148:151], v[28:31]
s_waitcnt lgkmcnt(1)
v_mfma_f32_16x16x32_bf16 v[28:31], v[88:91], v[152:155], v[28:31]
s_waitcnt lgkmcnt(0)
v_mfma_f32_16x16x32_bf16 v[28:31], v[92:95], v[156:159], v[28:31]
s_mov_b32 exec_lo, 0x000f000f
s_mov_b32 exec_hi, 0x000f000f
s_nop 5
ds_write_b128 v210, v[28:31] offset:7168
s_mov_b64 exec, -1
s_waitcnt lgkmcnt(0)
s_barrier
s_cmp_lg_u32 s4, 1
s_cbranch_scc1 L_w_end
ds_read_b128 v[28:31], v212 offset:7168
ds_read_b128 v[32:35], v212 offset:7424
ds_read_b128 v[36:39], v212 offset:7680
ds_read_b128 v[40:43], v212 offset:7936
s_waitcnt lgkmcnt(0)
v_pk_add_f32 v[28:29], v[28:29], v[32:33]
v_pk_add_f32 v[30:31], v[30:31], v[34:35]
v_pk_add_f32 v[36:37], v[36:37], v[40:41]
v_pk_add_f32 v[38:39], v[38:39], v[42:43]
v_pk_add_f32 v[28:29], v[28:29], v[36:37]
v_pk_add_f32 v[30:31], v[30:31], v[38:39]
buffer_store_dwordx4 v[28:31], v213, s[8:11], s45 offen sc1
s_endpgm
L_w_sp:
s_lshl_b32 s38, s5, 5
s_add_u32 s38, s38, s99
s_lshl_b32 s38, s38, 7
s_add_u32 s38, s38, 98304
s_mov_b32 s14, 262144
L_wf_65:
ds_read_b32 v3, v2 offset:272
s_waitcnt lgkmcnt(0)
v_cmp_gt_i32 vcc, 6, v3
s_cbranch_vccz L_wd_66
s_sub_u32 s14, s14, 1
s_cbranch_scc0 L_wf_65
L_wd_66:
ds_read2_b32 v[4:5], v24 offset0:92 offset1:94
ds_read2_b32 v[6:7], v24 offset0:96 offset1:98
ds_read2_b32 v[8:9], v24 offset0:100 offset1:102
s_waitcnt lgkmcnt(0)
v_add_f32 v4, v4, v5
v_add_f32 v6, v6, v7
v_add_f32 v8, v8, v9
v_add_f32 v4, v4, v6
v_add_f32 v5, v4, v8
v_readlane_b32 s36, v49, 16
v_readlane_b32 s39, v5, 16
s_cmp_eq_u32 s98, 2
s_cselect_b64 vcc, -1, 0
v_lshrrev_b32 v4, 16, v49
v_or_b32 v4, s36, v4
v_mov_b32 v6, s39
v_mov_b32 v7, s12
s_mov_b64 exec, 0xff
s_cbranch_vccz L_sl_67
buffer_store_dwordx4 v[4:7], v1, s[8:11], s38 offen
s_branch L_sl_68
L_sl_67:
buffer_store_dwordx4 v[4:7], v1, s[8:11], s38 offen sc1
L_sl_68:
s_mov_b64 exec, -1
s_cmp_eq_u32 s6, 7
s_cbranch_scc1 L_w_gu
s_cmp_eq_u32 s7, 3
s_cbranch_scc1 L_w_gu
v_mov_b32 v48, 0xff7fff7f
v_mov_b32 v49, 0
v_mov_b32 v50, 0
s_setprio 0
s_mov_b32 s14, 262144
L_wf_69:
ds_read_b32 v3, v2 offset:0
s_waitcnt lgkmcnt(0)
v_cmp_gt_i32 vcc, 160, v3
s_cbranch_vccz L_wd_70
s_sleep 1
s_sub_u32 s14, s14, 1
s_cbranch_scc0 L_wf_69
L_wd_70:
s_mov_b64 exec, 0xffffff
s_mov_b32 s14, 262144
L_pl_71:
buffer_load_dwordx4 v[48:51], v198, s[8:11], s47 offen sc1
s_waitcnt vmcnt(0)
v_cmp_ne_u32 vcc, s12, v51
s_cbranch_vccz L_pd_72
s_sub_u32 s14, s14, 1
s_cbranch_scc0 L_pl_71
L_pd_72:
s_mov_b64 exec, -1
v_lshlrev_b32 v4, 16, v48
v_and_b32 v5, 0xffff0000, v48
v_cndmask_b32 v6, v4, v5, s[48:49]
v_cndmask_b32 v7, v49, v50, s[48:49]
v_mov_b32 v4, v6
s_nop 1
v_max_f32_dpp v4, v4, v4 row_ror:1 row_mask:0xf bank_mask:0xf
s_nop 1
v_max_f32_dpp v4, v4, v4 row_ror:2 row_mask:0xf bank_mask:0xf
s_nop 1
v_max_f32_dpp v4, v4, v4 row_ror:4 row_mask:0xf bank_mask:0xf
s_nop 1
v_max_f32_dpp v4, v4, v4 row_ror:8 row_mask:0xf bank_mask:0xf
s_nop 1
v_max_f32_dpp v4, v4, v4 row_bcast:15 row_mask:0xa bank_mask:0xf
s_nop 1
v_max_f32_dpp v4, v4, v4 row_bcast:31 row_mask:0xc bank_mask:0xf
s_nop 0
v_readlane_b32 s36, v4, 63
s_nop 1
v_subrev_f32 v6, s36, v6
v_mul_f32 v6, 1035512379, v6
v_exp_f32 v6, v6
s_nop 0
v_mul_f32 v4, v6, v7
s_nop 1
v_add_f32_dpp v4, v4, v4 row_ror:1 row_mask:0xf bank_mask:0xf
s_nop 1
v_add_f32_dpp v4, v4, v4 row_ror:2 row_mask:0xf bank_mask:0xf
s_nop 1
v_add_f32_dpp v4, v4, v4 row_ror:4 row_mask:0xf bank_mask:0xf
s_nop 1
v_add_f32_dpp v4, v4, v4 row_ror:8 row_mask:0xf bank_mask:0xf
s_nop 1
v_add_f32_dpp v4, v4, v4 row_bcast:15 row_mask:0xa bank_mask:0xf
s_nop 1
v_add_f32_dpp v4, v4, v4 row_bcast:31 row_mask:0xc bank_mask:0xf
s_nop 0
v_readlane_b32 s36, v4, 63
s_nop 1
v_rcp_f32 v4, s36
s_nop 0
v_mul_f32 v6, v6, v4
s_mov_b32 exec_hi, 0
ds_write_b32 v214, v6 offset:8320
s_mov_b64 exec, -1
ds_write_b32 v2, v15 offset:300
s_waitcnt lgkmcnt(0)
s_endpgm
L_w_ctl:
v_mov_b32 v27, 0
v_mov_b32 v204, 0
v_mov_b32 v213, 0
v_and_b32 v4, 3, v0
v_bfe_u32 v3, v0, 2, 3
v_lshl_add_u32 v3, v4, 3, v3
v_lshl_add_u32 v25, v3, 2, v2
s_lshl_b32 s38, s5, 5
s_add_u32 s38, s38, s6
s_lshl_b32 s38, s38, 7
s_add_u32 s38, s38, 163840
s_add_u32 s42, s97, 65536
v_lshl_add_u32 v24, v0, 3, v2
v_lshrrev_b32 v3, 2, v0
v_lshlrev_b32 v5, 4, v4
v_lshl_add_u32 v26, v3, 7, v5
v_lshrrev_b32 v3, 5, v0
v_mul_u32_u24 v6, 5376, v3
v_lshrrev_b32 v3, 3, v198
v_add_u32 v6, v6, v3
s_mov_b64 s[16:17], s[84:85]
s_mov_b32 s18, 2408448
s_mov_b32 s19, 0x20000
s_mul_i32 s43, s99, 107520
s_lshl_b32 s36, s5, 9
s_add_u32 s43, s43, s36
s_addk_i32 s43, 1792
s_mov_b32 s14, 262144
L_wf_73:
ds_read_b32 v3, v2 offset:0
s_waitcnt lgkmcnt(0)
v_cmp_gt_i32 vcc, 32, v3
s_cbranch_vccz L_wd_74
s_sleep 2
s_sub_u32 s14, s14, 1
s_cbranch_scc0 L_wf_73
L_wd_74:
s_mov_b32 s14, 262144
L_w_c0:
s_load_dword s36, s[8:9], s38 glc
s_waitcnt lgkmcnt(0)
s_cmp_eq_u32 s36, s12
s_cbranch_scc1 L_w_c1
s_sub_u32 s14, s14, 1
s_cbranch_scc0 L_w_c0
L_w_c1:
buffer_load_dwordx4 v[64:67], v26, s[8:11], s42 offen sc1
buffer_load_dwordx4 v[68:71], v26, s[8:11], s42 offen offset:2048 sc1
s_sleep 10
s_mov_b32 s14, 262144
L_w_c4:
buffer_load_dwordx4 v[72:75], v26, s[8:11], s42 offen sc1
buffer_load_dwordx4 v[76:79], v26, s[8:11], s42 offen offset:2048 sc1
s_waitcnt vmcnt(2)
v_xor_b32 v3, s12, v66
v_xor_b32 v4, s12, v70
v_or_b32 v3, v3, v4
v_cmp_ne_u32 vcc, 0, v3
s_cbranch_vccz L_w_c5_0
s_sleep 10
buffer_load_dwordx4 v[64:67], v26, s[8:11], s42 offen sc1
buffer_load_dwordx4 v[68:71], v26, s[8:11], s42 offen offset:2048 sc1
s_waitcnt vmcnt(2)
v_xor_b32 v3, s12, v74
v_xor_b32 v4, s12, v78
v_or_b32 v3, v3, v4
v_cmp_ne_u32 vcc, 0, v3
s_cbranch_vccz L_w_c5_1
s_sleep 10
s_sub_u32 s14, s14, 1
s_cbranch_scc0 L_w_c4
L_w_c5_0:
ds_write_b64 v24, v[64:65] offset:1024
ds_write_b64 v24, v[68:69] offset:1536
v_add_u32 v3, 1, v67
s_branch L_w_c6
L_w_c5_1:
ds_write_b64 v24, v[72:73] offset:1024
ds_write_b64 v24, v[76:77] offset:1536
v_add_u32 v3, 1, v75
L_w_c6:
s_mov_b64 exec, 1
ds_write_b32 v2, v3 offset:268
s_mov_b64 exec, -1
L_w_gu:
s_setprio 0
s_cmp_eq_u32 s5, 7
s_cbranch_scc1 L_w_end
s_add_u32 s36, s7, 7
s_cmp_eq_u32 s6, 7
s_cselect_b32 s36, s36, 99
s_cmp_eq_u32 s7, 3
s_cselect_b32 s36, s6, s36
s_cmp_gt_u32 s36, 9
s_cbranch_scc1 L_w_end
s_mul_i32 s36, s36, 3
s_add_u32 s36, s36, s4
s_sub_u32 s44, s36, 5
s_sub_u32 s37, s44, 15
s_cmp_ge_u32 s44, 15
s_cselect_b32 s36, s37, s44
s_load_dwordx4 s[16:19], s[0:1], 48
s_load_dwordx2 s[20:21], s[0:1], 64
v_lshrrev_b32 v3, 5, v0
v_mul_u32_u24 v6, 3584, v3
v_lshrrev_b32 v3, 3, v198
v_add_u32 v6, v6, v3
s_waitcnt lgkmcnt(0)
s_cselect_b64 s[16:17], s[18:19], s[16:17]
s_mov_b32 s18, 1605632
s_mov_b32 s19, 0x20000
s_mul_i32 s43, s36, 107520
s_lshl_b32 s36, s5, 9
s_add_u32 s43, s43, s36
s_mul_i32 s36, s5, 229376
s_mulk_i32 s44, 7680
s_add_u32 s44, s44, s36
s_add_u32 s22, s36, 229376
s_mov_b32 s23, 0x20000
s_lshl_b32 s36, s15, 1
s_sub_u32 s36, s36, 28
s_mov_b32 s14, 262144
L_wf_75:
ds_read_b32 v3, v2 offset:0
s_waitcnt lgkmcnt(0)
v_cmp_gt_i32 vcc, s36, v3
s_cbranch_vccz L_wd_76
s_sleep 1
s_sub_u32 s14, s14, 1
s_cbranch_scc0 L_wf_75
L_wd_76:
buffer_load_dwordx4 v[240:243], v6, s[16:19], s43 offen
s_addk_i32 s43, 7168
s_waitcnt vmcnt(4)
buffer_load_dwordx4 v[240:243], v6, s[16:19], s43 offen
s_addk_i32 s43, 7168
s_waitcnt vmcnt(4)
buffer_load_dwordx4 v[240:243], v6, s[16:19], s43 offen
s_addk_i32 s43, 7168
s_waitcnt vmcnt(4)
buffer_load_dwordx4 v[240:243], v6, s[16:19], s43 offen
s_addk_i32 s43, 7168
s_waitcnt vmcnt(4)
buffer_load_dwordx4 v[240:243], v6, s[16:19], s43 offen
s_addk_i32 s43, 7168
s_waitcnt vmcnt(4)
buffer_load_dwordx4 v[240:243], v6, s[16:19], s43 offen
s_addk_i32 s43, 7168
s_waitcnt vmcnt(4)
buffer_load_dwordx4 v[240:243], v6, s[16:19], s43 offen
s_addk_i32 s43, 7168
s_waitcnt vmcnt(4)
buffer_load_dwordx4 v[240:243], v6, s[16:19], s43 offen
s_addk_i32 s43, 7168
s_waitcnt vmcnt(4)
buffer_load_dwordx4 v[240:243], v6, s[16:19], s43 offen
s_addk_i32 s43, 7168
s_waitcnt vmcnt(4)
buffer_load_dwordx4 v[240:243], v6, s[16:19], s43 offen
s_addk_i32 s43, 7168
s_waitcnt vmcnt(4)
buffer_load_dwordx4 v[240:243], v6, s[16:19], s43 offen
s_addk_i32 s43, 7168
s_waitcnt vmcnt(4)
buffer_load_dwordx4 v[240:243], v6, s[16:19], s43 offen
s_addk_i32 s43, 7168
s_waitcnt vmcnt(4)
buffer_load_dwordx4 v[240:243], v6, s[16:19], s43 offen
s_addk_i32 s43, 7168
s_waitcnt vmcnt(4)
buffer_load_dwordx4 v[240:243], v6, s[16:19], s43 offen
s_addk_i32 s43, 7168
s_waitcnt vmcnt(4)
buffer_load_dwordx4 v[240:243], v6, s[16:19], s43 offen
s_addk_i32 s43, 7168
s_waitcnt vmcnt(4)
buffer_load_dwordx4 v[240:243], v1, s[20:23], s44 offen
s_addk_i32 s44, 1024
s_waitcnt vmcnt(4)
buffer_load_dwordx4 v[240:243], v1, s[20:23], s44 offen
s_addk_i32 s44, 1024
s_waitcnt vmcnt(4)
buffer_load_dwordx4 v[240:243], v1, s[20:23], s44 offen
s_addk_i32 s44, 1024
s_waitcnt vmcnt(4)
buffer_load_dwordx4 v[240:243], v1, s[20:23], s44 offen
s_addk_i32 s44, 1024
s_waitcnt vmcnt(4)
buffer_load_dwordx4 v[240:243], v1, s[20:23], s44 offen
s_addk_i32 s44, 1024
s_waitcnt vmcnt(4)
buffer_load_dwordx4 v[240:243], v1, s[20:23], s44 offen
s_addk_i32 s44, 1024
s_waitcnt vmcnt(4)
buffer_load_dwordx4 v[240:243], v1, s[20:23], s44 offen
s_addk_i32 s44, 1024
s_waitcnt vmcnt(4)
buffer_load_dwordx4 v[240:243], v1, s[20:23], s44 offen
s_addk_i32 s44, 1024
s_waitcnt vmcnt(4)
s_endpgm
L_w_ffn:
s_cmp_lg_u32 s5, 7
s_cbranch_scc1 L_w_f0
s_cmp_lg_u32 s4, 7
s_cbranch_scc1 L_w_g7
s_lshl_b32 s36, s6, 2
s_add_u32 s38, s36, 36864
v_mov_b32 v4, s12
v_lshlrev_b32 v5, 7, v0
s_mov_b64 exec, 0xff
buffer_store_dword v4, v5, s[8:11], s38 offen sc1
s_mov_b64 exec, -1
L_w_g7:
s_endpgm
L_w_f0:
s_lshl_b32 s42, s5, 3
s_add_u32 s42, s42, s6
s_mov_b64 s[16:17], s[84:85]
s_mov_b32 s18, 2408448
s_mov_b32 s19, 0x20000
s_mov_b64 s[20:21], s[76:77]
s_mov_b32 s22, 1605632
s_mov_b32 s23, 0x20000
s_mov_b64 s[24:25], s[78:79]
s_mov_b32 s26, 1605632
s_mov_b32 s27, 0x20000
s_mov_b64 s[28:29], s[80:81]
s_mov_b32 s30, 1605632
s_mov_b32 s31, 0x20000
v_bfe_u32 v3, v0, 4, 1
v_lshlrev_b32 v3, 1, v3
v_and_b32 v4, 7, v0
v_xor_b32 v3, v3, v4
v_lshlrev_b32 v9, 4, v3
v_lshrrev_b32 v3, 3, v0
v_mul_u32_u24 v6, 5376, v3
v_add_u32 v6, v6, v9
v_xor_b32 v7, 64, v6
v_lshrrev_b32 v3, 3, v0
v_mul_u32_u24 v12, 896, v3
v_add_u32 v12, v12, v9
v_xor_b32 v13, 64, v12
v_lshrrev_b32 v10, 2, v0
v_bfe_u32 v3, v0, 5, 1
v_lshlrev_b32 v3, 1, v3
v_and_b32 v4, 3, v0
v_xor_b32 v3, v3, v4
v_mul_u32_u24 v10, 3584, v10
v_lshl_add_u32 v10, v3, 4, v10
v_xor_b32 v11, 16, v10
s_and_b32 s36, s42, 1
s_mul_i32 s36, s36, 7
s_add_u32 s36, s36, s13
s_mul_i32 s36, s36, 172032
s_lshr_b32 s37, s42, 1
s_lshl_b32 s37, s37, 7
s_add_u32 s36, s36, s37
s_add_u32 s44, s36, 1792
s_mul_i32 s45, s13, 229376
s_lshl_b32 s37, s42, 6
s_add_u32 s45, s45, s37
s_mov_b32 s46, s45
s_mul_i32 s47, s42, 28672
s_add_u32 s47, s47, s43
s_lshl_b32 s48, s13, 12
s_mov_b32 s14, 262144
L_wf_77:
ds_read_b32 v3, v2 offset:264
s_waitcnt lgkmcnt(0)
v_cmp_gt_i32 vcc, 4, v3
s_cbranch_vccz L_wd_78
s_sleep 1
s_sub_u32 s14, s14, 1
s_cbranch_scc0 L_wf_77
L_wd_78:
s_add_u32 m0, s48, 57344
s_nop 0
buffer_load_dwordx4 v6, s[16:19], s44 offen lds
s_addk_i32 m0, 1024
s_add_u32 s44, s44, 43008
buffer_load_dwordx4 v7, s[16:19], s44 offen lds
s_addk_i32 m0, 1024
s_add_u32 s44, s44, 43008
buffer_load_dwordx4 v6, s[16:19], s44 offen lds
s_addk_i32 m0, 1024
s_add_u32 s44, s44, 43008
buffer_load_dwordx4 v7, s[16:19], s44 offen lds
s_cmp_lg_u32 s4, 7
s_cbranch_scc1 L_w_f1
s_lshl_b32 s36, s5, 7
s_add_u32 s38, s36, 36864
s_mov_b32 s14, 262144
L_cc_79:
s_load_dwordx8 s[88:95], s[8:9], s38 glc
s_waitcnt lgkmcnt(0)
s_xor_b32 s36, s88, s12
s_xor_b32 s37, s89, s12
s_or_b32 s36, s36, s37
s_xor_b32 s37, s90, s12
s_or_b32 s36, s36, s37
s_xor_b32 s37, s91, s12
s_or_b32 s36, s36, s37
s_xor_b32 s37, s92, s12
s_or_b32 s36, s36, s37
s_xor_b32 s37, s93, s12
s_or_b32 s36, s36, s37
s_xor_b32 s37, s94, s12
s_or_b32 s36, s36, s37
s_xor_b32 s37, s95, s12
s_or_b32 s36, s36, s37
s_cbranch_scc0 L_cc_80
s_sleep 8
s_sub_u32 s14, s14, 1
s_cbranch_scc0 L_cc_79
L_cc_80:
s_mov_b64 exec, 1
ds_add_u32 v2, v15 offset:300
s_mov_b64 exec, -1
L_w_f1:
v_lshl_add_u32 v3, v16, 2, v17
s_lshl_b32 s36, s13, 6
v_add_u32 v3, s36, v3
v_lshl_add_u32 v176, v3, 1, v2
v_lshlrev_b32 v177, 2, v3
v_add_u32 v191, v2, v177
ds_read_u16 v19, v176 offset:7168
v_mul_u32_u24 v178, 1792, v17
v_lshl_add_u32 v178, v16, 4, v178
s_and_b32 s52, s5, 3
s_mul_i32 s52, s52, 28672
s_lshl_b32 s36, s13, 8
s_add_u32 s52, s52, s36
s_add_u32 s52, s52, 983040
s_add_u32 s53, s52, 7168
s_add_u32 s54, s52, 14336
s_add_u32 s55, s52, 21504
s_mov_b32 s56, 917504
s_mov_b32 s57, 924672
s_mov_b32 s58, 931840
v_lshlrev_b32 v54, 1, v177
v_lshrrev_b32 v3, 2, v16
v_lshl_add_u32 v3, v17, 3, v3
v_lshlrev_b32 v179, 6, v3
v_bfe_u32 v3, v0, 4, 1
v_bfe_u32 v4, v0, 1, 1
v_lshl_or_b32 v3, v3, 1, v4
v_xor_b32 v3, s13, v3
v_lshl_add_u32 v179, v3, 4, v179
v_and_b32 v3, 1, v0
v_lshl_add_u32 v179, v3, 3, v179
v_mul_u32_u24 v4, 28672, v4
v_add_u32 v179, v179, v4
v_add_u32 v179, 86016, v179
s_lshl_b32 s39, s13, 12
v_add_u32 v180, s39, v14
v_xor_b32 v181, 32, v180
v_xor_b32 v182, 64, v180
v_xor_b32 v183, 96, v180
v_add_u32 v5, 8192, v25
v_mov_b32 v4, 147968
v_cmp_eq_u32 vcc, 0, v16
s_nop 1
v_cndmask_b32 v184, v4, v5, vcc
v_cmp_eq_u32 vcc, 1, v16
s_nop 1
v_cndmask_b32 v185, v4, v5, vcc
v_cmp_eq_u32 vcc, 2, v16
s_nop 1
v_cndmask_b32 v186, v4, v5, vcc
v_cmp_eq_u32 vcc, 3, v16
s_nop 1
v_cndmask_b32 v187, v4, v5, vcc
v_lshrrev_b32 v3, 1, v16
v_mul_u32_u24 v188, 7168, v3
v_and_b32 v3, 1, v0
v_lshl_add_u32 v188, v3, 6, v188
v_lshl_add_u32 v188, v17, 4, v188
s_lshl_b32 s49, s42, 7
s_mul_i32 s39, s13, 14336
s_add_u32 s49, s49, s39
s_add_u32 s49, s49, 786432
v_and_b32 v3, 3, v0
v_cmp_eq_u32 s[76:77], 1, v3
v_cmp_eq_u32 s[78:79], 3, v3
v_cmp_lt_u32 s[80:81], 1, v3
s_lshl_b32 s39, s13, 4
v_lshl_add_u32 v4, v17, 2, v3
v_lshl_add_u32 v4, v4, 1, v2
v_add_u32 v190, s39, v4
v_lshl_add_u32 v189, v0, 2, v2
v_mov_b32 v56, v12
v_mov_b32 v57, v13
v_and_b32 v3, 7, v0
v_lshl_add_u32 v3, v3, 2, v17
s_lshl_b32 s36, s42, 5
v_add_u32 v3, s36, v3
v_min_u32 v3, 447, v3
v_lshlrev_b32 v52, 1, v3
v_lshlrev_b32 v53, 2, v3
s_mov_b32 s59, 939008
s_waitcnt vmcnt(0)
s_mov_b64 exec, 1
ds_add_u32 v2, v15 offset:308
s_mov_b64 exec, -1
s_cmp_gt_u32 s4, 4
s_cbranch_scc1 L_w_f2
s_lshl_b32 s36, s13, 5
v_xor_b32 v24, s36, v14
v_add_u32 v24, 57344, v24
s_and_b32 s37, s42, 1
s_mul_i32 s38, s37, 448
v_add_u32 v26, s38, v25
s_lshr_b32 s38, s42, 1
s_mul_i32 s39, s38, 37
s_lshr_b32 s39, s39, 8
s_add_u32 s37, s37, s39
s_mul_i32 s37, s37, 3584
s_lshl_b32 s38, s38, 9
s_add_u32 s44, s37, s38
s_add_u32 s44, s44, s43
s_add_u32 s44, s44, 917504
v_lshlrev_b32 v27, 5, v17
v_lshl_add_u32 v27, v16, 4, v27
v_cmp_eq_u32 s[50:51], 0, v16
v_mov_b32 v33, s12
v_mov_b32 v35, s12
ds_read_b128 v[128:131], v26 offset:3712
ds_read_b128 v[132:135], v26 offset:3776
ds_read_b128 v[136:139], v26 offset:3840
ds_read_b128 v[140:143], v26 offset:3904
ds_read_b128 v[144:147], v26 offset:3968
ds_read_b128 v[148:151], v26 offset:4032
ds_read_b128 v[152:155], v26 offset:4096
s_mov_b32 s14, 262144
L_wf_81:
ds_read_b32 v3, v2 offset:308
s_waitcnt lgkmcnt(0)
v_cmp_gt_i32 vcc, 7, v3
s_cbranch_vccz L_wd_82
s_sleep 1
s_sub_u32 s14, s14, 1
s_cbranch_scc0 L_wf_81
L_wd_82:
ds_read_b64_tr_b16 v[64:65], v24 offset:0
ds_read_b64_tr_b16 v[66:67], v24 offset:512
ds_read_b64_tr_b16 v[68:69], v24 offset:4096
ds_read_b64_tr_b16 v[70:71], v24 offset:4608
ds_read_b64_tr_b16 v[72:73], v24 offset:8192
ds_read_b64_tr_b16 v[74:75], v24 offset:8704
ds_read_b64_tr_b16 v[76:77], v24 offset:12288
ds_read_b64_tr_b16 v[78:79], v24 offset:12800
ds_read_b64_tr_b16 v[80:81], v24 offset:16384
ds_read_b64_tr_b16 v[82:83], v24 offset:16896
ds_read_b64_tr_b16 v[84:85], v24 offset:20480
ds_read_b64_tr_b16 v[86:87], v24 offset:20992
ds_read_b64_tr_b16 v[88:89], v24 offset:24576
ds_read_b64_tr_b16 v[90:91], v24 offset:25088
s_waitcnt lgkmcnt(0)
v_mfma_f32_16x16x32_bf16 v[28:31], v[64:67], v[128:131], 0
v_mfma_f32_16x16x32_bf16 v[28:31], v[68:71], v[132:135], v[28:31]
v_mfma_f32_16x16x32_bf16 v[28:31], v[72:75], v[136:139], v[28:31]
v_mfma_f32_16x16x32_bf16 v[28:31], v[76:79], v[140:143], v[28:31]
v_mfma_f32_16x16x32_bf16 v[28:31], v[80:83], v[144:147], v[28:31]
v_mfma_f32_16x16x32_bf16 v[28:31], v[84:87], v[148:151], v[28:31]
v_mfma_f32_16x16x32_bf16 v[28:31], v[88:91], v[152:155], v[28:31]
s_nop 7
v_cndmask_b32 v32, v30, v28, s[50:51]
v_cndmask_b32 v34, v31, v29, s[50:51]
s_mov_b32 exec_lo, 0x00030003
s_mov_b32 exec_hi, 0x00030003
buffer_store_dwordx4 v[32:35], v27, s[8:11], s44 offen sc1
s_mov_b64 exec, -1
L_w_f2:
s_cmp_lg_u32 s4, 7
s_cbranch_scc1 L_go_83
s_lshl_b32 s38, s5, 16
s_add_u32 s38, s38, 262144
v_lshlrev_b32 v29, 4, v198
s_mov_b64 exec, 0xffffff
s_mov_b32 s14, 262144
L_pl_84:
buffer_load_dword v28, v29, s[8:11], s38 offen sc1
s_waitcnt vmcnt(0)
v_cmp_eq_u32 vcc, v20, v28
s_nop 0
s_bcnt1_i32_b64 s36, vcc
s_cmp_gt_u32 s36, 22
s_cselect_b64 vcc, -1, 0
s_cbranch_vccz L_pd_85
s_sleep 2
s_sub_u32 s14, s14, 1
s_cbranch_scc0 L_pl_84
L_pd_85:
s_mov_b64 exec, -1
ds_write_b32 v2, v15 offset:296
L_go_83:
s_mov_b32 s14, 262144
L_wf_86:
ds_read_b32 v3, v2 offset:296
s_waitcnt lgkmcnt(0)
v_cmp_gt_i32 vcc, 1, v3
s_cbranch_vccz L_wd_87
s_sleep 1
s_sub_u32 s14, s14, 1
s_cbranch_scc0 L_wf_86
L_wd_87:
buffer_load_dwordx2 v[136:137], v54, s[8:11], s56 offen offset:0 sc1
buffer_load_dwordx2 v[138:139], v54, s[8:11], s56 offen offset:3584 sc1
buffer_load_dwordx2 v[140:141], v54, s[8:11], s57 offen offset:0 sc1
buffer_load_dwordx2 v[142:143], v54, s[8:11], s57 offen offset:3584 sc1
buffer_load_dwordx2 v[144:145], v54, s[8:11], s58 offen offset:0 sc1
buffer_load_dwordx2 v[146:147], v54, s[8:11], s58 offen offset:3584 sc1
buffer_load_dwordx2 v[148:149], v54, s[8:11], s59 offen offset:0 sc1
buffer_load_dwordx2 v[150:151], v54, s[8:11], s59 offen offset:3584 sc1
s_mov_b32 s14, 262144
L_wf_91:
ds_read_b32 v3, v2 offset:296
s_waitcnt lgkmcnt(0)
v_cmp_gt_i32 vcc, 1, v3
s_cbranch_vccz L_wd_92
s_sleep 1
s_sub_u32 s14, s14, 1
s_cbranch_scc0 L_wf_91
L_wd_92:
s_add_u32 m0, s48, 86016
s_nop 0
buffer_load_dwordx4 v10, s[20:23], s45 offen lds
s_addk_i32 m0, 1024
s_add_u32 s45, s45, 57344
buffer_load_dwordx4 v10, s[20:23], s45 offen lds
s_addk_i32 m0, 1024
s_add_u32 s45, s45, 57344
buffer_load_dwordx4 v10, s[20:23], s45 offen lds
s_addk_i32 m0, 1024
s_add_u32 s45, s45, 57344
buffer_load_dwordx4 v10, s[20:23], s45 offen lds
s_add_u32 m0, s48, 114688
s_nop 0
buffer_load_dwordx4 v11, s[24:27], s46 offen lds
s_addk_i32 m0, 1024
s_add_u32 s46, s46, 57344
buffer_load_dwordx4 v11, s[24:27], s46 offen lds
s_addk_i32 m0, 1024
s_add_u32 s46, s46, 57344
buffer_load_dwordx4 v11, s[24:27], s46 offen lds
s_addk_i32 m0, 1024
s_add_u32 s46, s46, 57344
buffer_load_dwordx4 v11, s[24:27], s46 offen lds
s_mov_b64 s[24:25], s[86:87]
s_mov_b32 s26, 896
s_mov_b32 s27, 0x20000
s_mul_i32 s45, s42, 7168
s_add_u32 s45, s45, 786432
s_add_u32 s46, s45, 4096
s_mov_b32 s14, 262144
s_waitcnt vmcnt(15)
v_cmp_ne_u32 vcc, s12, v137
s_nop 0
s_mov_b64 s[60:61], vcc
s_mov_b64 s[36:37], vcc
s_waitcnt vmcnt(14)
v_cmp_ne_u32 vcc, s12, v139
s_nop 0
s_mov_b64 s[62:63], vcc
s_or_b64 s[36:37], s[36:37], vcc
s_waitcnt vmcnt(13)
v_cmp_ne_u32 vcc, s12, v141
s_nop 0
s_mov_b64 s[64:65], vcc
s_or_b64 s[36:37], s[36:37], vcc
s_waitcnt vmcnt(12)
v_cmp_ne_u32 vcc, s12, v143
s_nop 0
s_mov_b64 s[66:67], vcc
s_or_b64 s[36:37], s[36:37], vcc
s_waitcnt vmcnt(11)
v_cmp_ne_u32 vcc, s12, v145
s_nop 0
s_mov_b64 s[68:69], vcc
s_or_b64 s[36:37], s[36:37], vcc
s_waitcnt vmcnt(10)
v_cmp_ne_u32 vcc, s12, v147
s_nop 0
s_mov_b64 s[70:71], vcc
s_or_b64 s[36:37], s[36:37], vcc
s_waitcnt vmcnt(9)
v_cmp_ne_u32 vcc, s12, v149
s_nop 0
s_mov_b64 s[72:73], vcc
s_or_b64 s[36:37], s[36:37], vcc
s_waitcnt vmcnt(8)
v_cmp_ne_u32 vcc, s12, v151
s_nop 0
s_mov_b64 s[74:75], vcc
s_or_b64 s[36:37], s[36:37], vcc
s_cmp_eq_u64 s[36:37], 0
s_cbranch_scc1 L_gd_90
L_g_88:
s_sleep 2
s_mov_b64 exec, s[60:61]
s_cbranch_execz L_gs_93
buffer_load_dwordx2 v[136:137], v54, s[8:11], s56 offen offset:0 sc1
L_gs_93:
s_mov_b64 exec, s[62:63]
s_cbranch_execz L_gs_94
buffer_load_dwordx2 v[138:139], v54, s[8:11], s56 offen offset:3584 sc1
L_gs_94:
s_mov_b64 exec, s[64:65]
s_cbranch_execz L_gs_95
buffer_load_dwordx2 v[140:141], v54, s[8:11], s57 offen offset:0 sc1
L_gs_95:
s_mov_b64 exec, s[66:67]
s_cbranch_execz L_gs_96
buffer_load_dwordx2 v[142:143], v54, s[8:11], s57 offen offset:3584 sc1
L_gs_96:
s_mov_b64 exec, s[68:69]
s_cbranch_execz L_gs_97
buffer_load_dwordx2 v[144:145], v54, s[8:11], s58 offen offset:0 sc1
L_gs_97:
s_mov_b64 exec, s[70:71]
s_cbranch_execz L_gs_98
buffer_load_dwordx2 v[146:147], v54, s[8:11], s58 offen offset:3584 sc1
L_gs_98:
s_mov_b64 exec, s[72:73]
s_cbranch_execz L_gs_99
buffer_load_dwordx2 v[148:149], v54, s[8:11], s59 offen offset:0 sc1
L_gs_99:
s_mov_b64 exec, s[74:75]
s_cbranch_execz L_gs_100
buffer_load_dwordx2 v[150:151], v54, s[8:11], s59 offen offset:3584 sc1
L_gs_100:
s_mov_b64 s[36:37], 0
s_waitcnt vmcnt(0)
s_mov_b64 exec, s[60:61]
s_cbranch_execz L_gs_101
v_cmp_ne_u32 vcc, s12, v137
s_nop 0
s_mov_b64 s[60:61], vcc
s_or_b64 s[36:37], s[36:37], vcc
L_gs_101:
s_mov_b64 exec, s[62:63]
s_cbranch_execz L_gs_102
v_cmp_ne_u32 vcc, s12, v139
s_nop 0
s_mov_b64 s[62:63], vcc
s_or_b64 s[36:37], s[36:37], vcc
L_gs_102:
s_mov_b64 exec, s[64:65]
s_cbranch_execz L_gs_103
v_cmp_ne_u32 vcc, s12, v141
s_nop 0
s_mov_b64 s[64:65], vcc
s_or_b64 s[36:37], s[36:37], vcc
L_gs_103:
s_mov_b64 exec, s[66:67]
s_cbranch_execz L_gs_104
v_cmp_ne_u32 vcc, s12, v143
s_nop 0
s_mov_b64 s[66:67], vcc
s_or_b64 s[36:37], s[36:37], vcc
L_gs_104:
s_mov_b64 exec, s[68:69]
s_cbranch_execz L_gs_105
v_cmp_ne_u32 vcc, s12, v145
s_nop 0
s_mov_b64 s[68:69], vcc
s_or_b64 s[36:37], s[36:37], vcc
L_gs_105:
s_mov_b64 exec, s[70:71]
s_cbranch_execz L_gs_106
v_cmp_ne_u32 vcc, s12, v147
s_nop 0
s_mov_b64 s[70:71], vcc
s_or_b64 s[36:37], s[36:37], vcc
L_gs_106:
s_mov_b64 exec, s[72:73]
s_cbranch_execz L_gs_107
v_cmp_ne_u32 vcc, s12, v149
s_nop 0
s_mov_b64 s[72:73], vcc
s_or_b64 s[36:37], s[36:37], vcc
L_gs_107:
s_mov_b64 exec, s[74:75]
s_cbranch_execz L_gs_108
v_cmp_ne_u32 vcc, s12, v151
s_nop 0
s_mov_b64 s[74:75], vcc
s_or_b64 s[36:37], s[36:37], vcc
L_gs_108:
s_mov_b64 exec, -1
s_cmp_eq_u64 s[36:37], 0
s_cbranch_scc1 L_gd_90
s_sub_u32 s14, s14, 1
s_cbranch_scc0 L_g_88
L_gd_90:
v_add_f32 v40, v136, v138
v_add_f32 v41, v140, v142
v_add_f32 v42, v144, v146
v_add_f32 v43, v148, v150
ds_write_b32 v191, v43 offset:1024
s_mov_b64 exec, 1
ds_add_u32 v2, v15 offset:300
s_mov_b64 exec, -1
v_cvt_pk_bf16_f32 v40, 0, v40
v_cvt_pk_bf16_f32 v41, 0, v41
v_cvt_pk_bf16_f32 v42, 0, v42
v_add_f32 v42, 1.0, v42
v_cvt_pk_bf16_f32 v42, 0, v42
v_lshlrev_b32 v19, 16, v19
s_waitcnt vmcnt(0)
s_mov_b64 exec, 1
ds_add_u32 v2, v15 offset:312
s_mov_b64 exec, -1
s_cmp_gt_u32 s4, 4
s_cbranch_scc1 L_w_f3
s_mov_b32 s14, 262144
L_wf_109:
ds_read_b32 v3, v2 offset:312
s_waitcnt lgkmcnt(0)
v_cmp_gt_i32 vcc, 7, v3
s_cbranch_vccz L_wd_110
s_sleep 1
s_sub_u32 s14, s14, 1
s_cbranch_scc0 L_wf_109
L_wd_110:
ds_read_b64_tr_b16 v[64:65], v179 offset:0
ds_read_b64_tr_b16 v[66:67], v179 offset:256
ds_read_b64_tr_b16 v[68:69], v179 offset:2048
ds_read_b64_tr_b16 v[70:71], v179 offset:2304
ds_read_b64_tr_b16 v[72:73], v179 offset:4096
ds_read_b64_tr_b16 v[74:75], v179 offset:4352
ds_read_b64_tr_b16 v[76:77], v179 offset:6144
ds_read_b64_tr_b16 v[78:79], v179 offset:6400
ds_read_b64_tr_b16 v[80:81], v179 offset:8192
ds_read_b64_tr_b16 v[82:83], v179 offset:8448
ds_read_b64_tr_b16 v[84:85], v179 offset:10240
ds_read_b64_tr_b16 v[86:87], v179 offset:10496
ds_read_b64_tr_b16 v[88:89], v179 offset:12288
ds_read_b64_tr_b16 v[90:91], v179 offset:12544
ds_read_b64_tr_b16 v[92:93], v179 offset:14336
ds_read_b64_tr_b16 v[94:95], v179 offset:14592
ds_read_b64_tr_b16 v[96:97], v179 offset:16384
ds_read_b64_tr_b16 v[98:99], v179 offset:16640
ds_read_b64_tr_b16 v[100:101], v179 offset:18432
ds_read_b64_tr_b16 v[102:103], v179 offset:18688
ds_read_b64_tr_b16 v[104:105], v179 offset:20480
ds_read_b64_tr_b16 v[106:107], v179 offset:20736
ds_read_b64_tr_b16 v[108:109], v179 offset:22528
ds_read_b64_tr_b16 v[110:111], v179 offset:22784
ds_read_b64_tr_b16 v[112:113], v179 offset:24576
ds_read_b64_tr_b16 v[114:115], v179 offset:24832
ds_read_b64_tr_b16 v[116:117], v179 offset:26624
ds_read_b64_tr_b16 v[118:119], v179 offset:26880
L_w_f3:
s_mov_b32 s14, 262144
L_wf_111:
ds_read_b32 v3, v2 offset:300
s_waitcnt lgkmcnt(0)
v_cmp_gt_i32 vcc, 8, v3
s_cbranch_vccz L_wd_112
s_sleep 1
s_sub_u32 s14, s14, 1
s_cbranch_scc0 L_wf_111
L_wd_112:
buffer_load_dwordx4 v[136:139], v178, s[8:11], s52 offen sc1
buffer_load_dwordx4 v[140:143], v178, s[8:11], s53 offen sc1
buffer_load_dwordx4 v[144:147], v178, s[8:11], s54 offen sc1
buffer_load_dwordx4 v[148:151], v178, s[8:11], s55 offen sc1
s_mov_b32 s14, 262144
s_waitcnt vmcnt(3)
v_cmp_eq_u32 vcc, v20, v136
s_nop 0
s_mov_b64 s[60:61], vcc
s_mov_b64 s[36:37], vcc
s_waitcnt vmcnt(2)
v_cmp_eq_u32 vcc, v20, v140
s_nop 0
s_mov_b64 s[62:63], vcc
s_or_b64 s[36:37], s[36:37], vcc
s_waitcnt vmcnt(1)
v_cmp_eq_u32 vcc, v20, v144
s_nop 0
s_mov_b64 s[64:65], vcc
s_or_b64 s[36:37], s[36:37], vcc
s_waitcnt vmcnt(0)
v_cmp_eq_u32 vcc, v20, v148
s_nop 0
s_mov_b64 s[66:67], vcc
s_or_b64 s[36:37], s[36:37], vcc
s_cmp_eq_u64 s[36:37], 0
s_cbranch_scc1 L_gd_115
L_g_113:
s_mov_b64 exec, s[60:61]
s_cbranch_execz L_gs_116
buffer_load_dwordx4 v[136:139], v178, s[8:11], s52 offen sc1
L_gs_116:
s_mov_b64 exec, s[62:63]
s_cbranch_execz L_gs_117
buffer_load_dwordx4 v[140:143], v178, s[8:11], s53 offen sc1
L_gs_117:
s_mov_b64 exec, s[64:65]
s_cbranch_execz L_gs_118
buffer_load_dwordx4 v[144:147], v178, s[8:11], s54 offen sc1
L_gs_118:
s_mov_b64 exec, s[66:67]
s_cbranch_execz L_gs_119
buffer_load_dwordx4 v[148:151], v178, s[8:11], s55 offen sc1
L_gs_119:
s_mov_b64 s[36:37], 0
s_waitcnt vmcnt(0)
s_mov_b64 exec, s[60:61]
s_cbranch_execz L_gs_120
v_cmp_eq_u32 vcc, v20, v136
s_nop 0
s_mov_b64 s[60:61], vcc
s_or_b64 s[36:37], s[36:37], vcc
L_gs_120:
s_mov_b64 exec, s[62:63]
s_cbranch_execz L_gs_121
v_cmp_eq_u32 vcc, v20, v140
s_nop 0
s_mov_b64 s[62:63], vcc
s_or_b64 s[36:37], s[36:37], vcc
L_gs_121:
s_mov_b64 exec, s[64:65]
s_cbranch_execz L_gs_122
v_cmp_eq_u32 vcc, v20, v144
s_nop 0
s_mov_b64 s[64:65], vcc
s_or_b64 s[36:37], s[36:37], vcc
L_gs_122:
s_mov_b64 exec, s[66:67]
s_cbranch_execz L_gs_123
v_cmp_eq_u32 vcc, v20, v148
s_nop 0
s_mov_b64 s[66:67], vcc
s_or_b64 s[36:37], s[36:37], vcc
L_gs_123:
s_mov_b64 exec, -1
s_cmp_eq_u64 s[36:37], 0
s_cbranch_scc1 L_gd_115
s_sub_u32 s14, s14, 1
s_cbranch_scc0 L_g_113
L_gd_115:
v_pk_add_f32 v[136:137], v[136:137], v[140:141]
v_pk_add_f32 v[138:139], v[138:139], v[142:143]
v_pk_add_f32 v[144:145], v[144:145], v[148:149]
v_pk_add_f32 v[146:147], v[146:147], v[150:151]
v_pk_add_f32 v[136:137], v[136:137], v[144:145]
v_pk_add_f32 v[138:139], v[138:139], v[146:147]
s_nop 1
v_permlane32_swap_b32 v136, v138
v_permlane32_swap_b32 v137, v139
v_add_f32 v136, v136, v138
v_add_f32 v137, v137, v139
s_nop 1
v_permlane16_swap_b32 v136, v137
v_add_f32 v136, v136, v137
v_cvt_pk_bf16_f32 v36, 0, v136
v_mul_f32 v36, v40, v36
v_cvt_pk_bf16_f32 v36, 0, v36
v_add_f32 v19, v19, v36
v_cvt_pk_bf16_f32 v19, 0, v19
ds_write_b32 v191, v19 offset:4864
s_waitcnt lgkmcnt(0)
s_barrier
ds_read_b32 v13, v2 offset:4864
ds_read2st64_b32 v[6:7], v189 offset0:19 offset1:20
ds_read2st64_b32 v[8:9], v189 offset0:21 offset1:22
ds_read2st64_b32 v[10:11], v189 offset0:23 offset1:24
ds_read_b32 v12, v189 offset:6400
s_add_u32 m0, s48, 0
s_nop 0
buffer_load_dwordx4 v56, s[28:31], s47 offen lds
s_addk_i32 m0, 1024
s_add_u32 s47, s47, 7168
buffer_load_dwordx4 v57, s[28:31], s47 offen lds
s_addk_i32 m0, 1024
s_add_u32 s47, s47, 7168
buffer_load_dwordx4 v56, s[28:31], s47 offen lds
s_addk_i32 m0, 1024
s_add_u32 s47, s47, 7168
buffer_load_dwordx4 v57, s[28:31], s47 offen lds
s_waitcnt lgkmcnt(0)
v_sub_f32 v6, v6, v13
v_sub_f32 v7, v7, v13
v_sub_f32 v8, v8, v13
v_sub_f32 v9, v9, v13
v_sub_f32 v10, v10, v13
v_sub_f32 v11, v11, v13
v_sub_f32 v12, v12, v13
v_add_f32 v4, v6, v7
v_mul_f32 v5, v6, v6
v_fmac_f32 v5, v7, v7
v_add_f32 v4, v4, v8
v_fmac_f32 v5, v8, v8
v_add_f32 v4, v4, v9
v_fmac_f32 v5, v9, v9
v_add_f32 v4, v4, v10
v_fmac_f32 v5, v10, v10
v_add_f32 v4, v4, v11
v_fmac_f32 v5, v11, v11
v_add_f32 v4, v4, v12
v_fmac_f32 v5, v12, v12
s_nop 0
v_add_f32_dpp v4, v4, v4 row_ror:1 row_mask:0xf bank_mask:0xf
v_add_f32_dpp v5, v5, v5 row_ror:1 row_mask:0xf bank_mask:0xf
s_nop 0
v_add_f32_dpp v4, v4, v4 row_ror:2 row_mask:0xf bank_mask:0xf
v_add_f32_dpp v5, v5, v5 row_ror:2 row_mask:0xf bank_mask:0xf
s_nop 0
v_add_f32_dpp v4, v4, v4 row_ror:4 row_mask:0xf bank_mask:0xf
v_add_f32_dpp v5, v5, v5 row_ror:4 row_mask:0xf bank_mask:0xf
s_nop 0
v_add_f32_dpp v4, v4, v4 row_ror:8 row_mask:0xf bank_mask:0xf
v_add_f32_dpp v5, v5, v5 row_ror:8 row_mask:0xf bank_mask:0xf
s_nop 0
v_add_f32_dpp v4, v4, v4 row_bcast:15 row_mask:0xa bank_mask:0xf
v_add_f32_dpp v5, v5, v5 row_bcast:15 row_mask:0xa bank_mask:0xf
s_nop 0
v_add_f32_dpp v4, v4, v4 row_bcast:31 row_mask:0xc bank_mask:0xf
v_add_f32_dpp v5, v5, v5 row_bcast:31 row_mask:0xc bank_mask:0xf
v_readlane_b32 s37, v4, 63
v_readlane_b32 s38, v5, 63
v_mov_b32 v6, 0x3b124925
v_mul_f32 v4, s37, v6
v_mul_f32 v5, s38, v6
v_fma_f32 v5, -v4, v4, v5
v_add_f32 v4, v13, v4
v_max_f32 v5, 0, v5
v_cvt_pk_bf16_f32 v5, 0, v5
v_cvt_pk_bf16_f32 v4, 0, v4
v_add_f32 v5, 0x3727c5ac, v5
v_sub_f32 v4, v19, v4
v_cvt_pk_bf16_f32 v5, 0, v5
v_sqrt_f32 v5, v5
v_cvt_pk_bf16_f32 v4, 0, v4
v_cvt_pk_bf16_f32 v5, 0, v5
v_rcp_f32 v5, v5
s_nop 0
v_mul_f32 v28, v4, v5
v_cvt_pk_bf16_f32 v28, 0, v28
v_mul_f32 v28, v28, v42
v_cvt_pk_bf16_f32 v28, 0, v28
v_add_f32 v28, v28, v41
v_cvt_pk_bf16_f32 v28, v28, v28
ds_write_b16 v176, v28 offset:2816
s_waitcnt lgkmcnt(0)
s_barrier
s_cmp_le_u32 s4, 4
s_cbranch_scc1 L_w_f5a
s_waitcnt vmcnt(0)
ds_read_b64_tr_b16 v[120:121], v180 offset:0
ds_read_b64_tr_b16 v[122:123], v180 offset:512
ds_read_b64_tr_b16 v[124:125], v181 offset:0
ds_read_b64_tr_b16 v[126:127], v181 offset:512
ds_read_b64_tr_b16 v[128:129], v182 offset:0
ds_read_b64_tr_b16 v[130:131], v182 offset:512
ds_read_b64_tr_b16 v[132:133], v183 offset:0
ds_read_b64_tr_b16 v[134:135], v183 offset:512
s_cmp_lg_u32 s42, 0
s_cbranch_scc1 L_w_f4
s_cmp_lg_u32 s4, 6
s_cbranch_scc1 L_w_f4
s_mov_b64 exec, 1
v_mov_b32 v3, s12
buffer_store_dword v3, v1, s[8:11], 0 offen sc1
s_mov_b64 exec, -1
s_branch L_w_f4
L_w_f5a:
ds_read_b128 v[192:195], v25 offset:2816
ds_read_b128 v[196:199], v25 offset:2880
ds_read_b128 v[200:203], v25 offset:2944
ds_read_b128 v[204:207], v25 offset:3008
ds_read_b128 v[208:211], v25 offset:3072
ds_read_b128 v[212:215], v25 offset:3136
ds_read_b128 v[216:219], v25 offset:3200
ds_read_b128 v[220:223], v25 offset:3264
ds_read_b128 v[224:227], v25 offset:3328
ds_read_b128 v[228:231], v25 offset:3392
ds_read_b128 v[232:235], v25 offset:3456
ds_read_b128 v[236:239], v25 offset:3520
ds_read_b128 v[240:243], v25 offset:3584
ds_read_b128 v[244:247], v25 offset:3648
s_waitcnt lgkmcnt(13)
v_mfma_f32_16x16x32_bf16 v[28:31], v[64:67], v[192:195], 0
s_waitcnt lgkmcnt(12)
v_mfma_f32_16x16x32_bf16 v[28:31], v[68:71], v[196:199], v[28:31]
s_waitcnt lgkmcnt(11)
v_mfma_f32_16x16x32_bf16 v[28:31], v[72:75], v[200:203], v[28:31]
s_waitcnt lgkmcnt(10)
v_mfma_f32_16x16x32_bf16 v[28:31], v[76:79], v[204:207], v[28:31]
s_waitcnt lgkmcnt(9)
v_mfma_f32_16x16x32_bf16 v[28:31], v[80:83], v[208:211], v[28:31]
s_waitcnt lgkmcnt(8)
v_mfma_f32_16x16x32_bf16 v[28:31], v[84:87], v[212:215], v[28:31]
s_waitcnt lgkmcnt(7)
v_mfma_f32_16x16x32_bf16 v[28:31], v[88:91], v[216:219], v[28:31]
s_waitcnt lgkmcnt(6)
v_mfma_f32_16x16x32_bf16 v[28:31], v[92:95], v[220:223], v[28:31]
s_waitcnt lgkmcnt(5)
v_mfma_f32_16x16x32_bf16 v[28:31], v[96:99], v[224:227], v[28:31]
s_waitcnt lgkmcnt(4)
v_mfma_f32_16x16x32_bf16 v[28:31], v[100:103], v[228:231], v[28:31]
s_waitcnt lgkmcnt(3)
v_mfma_f32_16x16x32_bf16 v[28:31], v[104:107], v[232:235], v[28:31]
s_waitcnt lgkmcnt(2)
v_mfma_f32_16x16x32_bf16 v[28:31], v[108:111], v[236:239], v[28:31]
s_waitcnt lgkmcnt(1)
v_mfma_f32_16x16x32_bf16 v[28:31], v[112:115], v[240:243], v[28:31]
s_waitcnt lgkmcnt(0)
v_mfma_f32_16x16x32_bf16 v[28:31], v[116:119], v[244:247], v[28:31]
s_waitcnt vmcnt(0)
ds_read_b64_tr_b16 v[120:121], v180 offset:0
ds_read_b64_tr_b16 v[122:123], v180 offset:512
ds_read_b64_tr_b16 v[124:125], v181 offset:0
ds_read_b64_tr_b16 v[126:127], v181 offset:512
ds_read_b64_tr_b16 v[128:129], v182 offset:0
ds_read_b64_tr_b16 v[130:131], v182 offset:512
ds_read_b64_tr_b16 v[132:133], v183 offset:0
ds_read_b64_tr_b16 v[134:135], v183 offset:512
v_mov_b32 v32, 0xc0135761
v_cndmask_b32 v28, v28, v29, s[76:77]
v_cndmask_b32 v30, v30, v31, s[78:79]
v_cndmask_b32 v28, v28, v30, s[80:81]
v_cvt_pk_bf16_f32 v28, 0, v28
v_mov_b32 v29, v28
s_nop 1
v_permlane32_swap_b32 v28, v29
v_mul_f32 v30, v28, v28
v_fmac_f32 v32, 0xbdd2d3e8, v30
v_mul_f32 v30, v28, v32
v_exp_f32 v30, v30
s_nop 0
v_add_f32 v30, 1.0, v30
v_rcp_f32 v30, v30
s_nop 0
v_mul_f32 v28, v28, v30
v_cvt_pk_bf16_f32 v28, 0, v28
v_mul_f32 v28, v28, v29
v_cvt_pk_bf16_f32 v28, v28, v28
s_mov_b64 exec, 0x000f000f
ds_write_b16 v190, v28 offset:8192
s_mov_b64 exec, -1
L_w_f4:
v_add_u32 v53, v2, v53
s_waitcnt lgkmcnt(0)
s_barrier
ds_read_b128 v[136:139], v184
ds_read_b128 v[140:143], v185
ds_read_b128 v[144:147], v186
ds_read_b128 v[148:151], v187
ds_read_b32 v19, v53 offset:4864
ds_read_b32 v43, v53 offset:1024
s_waitcnt lgkmcnt(5)
v_mfma_f32_16x16x32_bf16 v[28:31], v[120:123], v[136:139], 0
s_waitcnt lgkmcnt(4)
v_mfma_f32_16x16x32_bf16 v[28:31], v[124:127], v[140:143], v[28:31]
s_waitcnt lgkmcnt(3)
v_mfma_f32_16x16x32_bf16 v[28:31], v[128:131], v[144:147], v[28:31]
s_waitcnt lgkmcnt(2)
v_mfma_f32_16x16x32_bf16 v[28:31], v[132:135], v[148:151], v[28:31]
s_mov_b32 exec_lo, 0x000f000f
s_mov_b32 exec_hi, 0x000f000f
s_nop 5
buffer_store_dwordx4 v[28:31], v188, s[8:11], s49 offen sc1
s_mov_b64 exec, -1
s_cmp_lg_u32 s4, 7
s_cbranch_scc1 L_w_end
s_cmp_ge_u32 s42, 14
s_cbranch_scc1 L_w_end
s_waitcnt lgkmcnt(0)
v_cvt_pk_bf16_f32 v43, 0, v43
s_sleep 10
buffer_load_dwordx4 v[64:67], v1, s[8:11], s45 offen offset:0 sc1
buffer_load_dwordx4 v[68:71], v1, s[8:11], s45 offen offset:1024 sc1
buffer_load_dwordx4 v[72:75], v1, s[8:11], s45 offen offset:2048 sc1
buffer_load_dwordx4 v[76:79], v1, s[8:11], s45 offen offset:3072 sc1
buffer_load_dwordx4 v[80:83], v1, s[8:11], s46 offen offset:0 sc1
buffer_load_dwordx4 v[84:87], v1, s[8:11], s46 offen offset:1024 sc1
buffer_load_dwordx4 v[88:91], v1, s[8:11], s46 offen offset:2048 sc1
s_mov_b32 s14, 262144
s_waitcnt vmcnt(6)
v_cmp_eq_u32 vcc, v20, v64
s_nop 0
s_mov_b64 s[60:61], vcc
s_mov_b64 s[36:37], vcc
s_waitcnt vmcnt(5)
v_cmp_eq_u32 vcc, v20, v68
s_nop 0
s_mov_b64 s[62:63], vcc
s_or_b64 s[36:37], s[36:37], vcc
s_waitcnt vmcnt(4)
v_cmp_eq_u32 vcc, v20, v72
s_nop 0
s_mov_b64 s[64:65], vcc
s_or_b64 s[36:37], s[36:37], vcc
s_waitcnt vmcnt(3)
v_cmp_eq_u32 vcc, v20, v76
s_nop 0
s_mov_b64 s[66:67], vcc
s_or_b64 s[36:37], s[36:37], vcc
s_waitcnt vmcnt(2)
v_cmp_eq_u32 vcc, v20, v80
s_nop 0
s_mov_b64 s[68:69], vcc
s_or_b64 s[36:37], s[36:37], vcc
s_waitcnt vmcnt(1)
v_cmp_eq_u32 vcc, v20, v84
s_nop 0
s_mov_b64 s[70:71], vcc
s_or_b64 s[36:37], s[36:37], vcc
s_waitcnt vmcnt(0)
v_cmp_eq_u32 vcc, v20, v88
s_nop 0
s_mov_b64 s[72:73], vcc
s_or_b64 s[36:37], s[36:37], vcc
s_cmp_eq_u64 s[36:37], 0
s_cbranch_scc1 L_gd_126
L_g_124:
s_mov_b64 exec, s[60:61]
s_cbranch_execz L_gs_127
buffer_load_dwordx4 v[64:67], v1, s[8:11], s45 offen offset:0 sc1
L_gs_127:
s_mov_b64 exec, s[62:63]
s_cbranch_execz L_gs_128
buffer_load_dwordx4 v[68:71], v1, s[8:11], s45 offen offset:1024 sc1
L_gs_128:
s_mov_b64 exec, s[64:65]
s_cbranch_execz L_gs_129
buffer_load_dwordx4 v[72:75], v1, s[8:11], s45 offen offset:2048 sc1
L_gs_129:
s_mov_b64 exec, s[66:67]
s_cbranch_execz L_gs_130
buffer_load_dwordx4 v[76:79], v1, s[8:11], s45 offen offset:3072 sc1
L_gs_130:
s_mov_b64 exec, s[68:69]
s_cbranch_execz L_gs_131
buffer_load_dwordx4 v[80:83], v1, s[8:11], s46 offen offset:0 sc1
L_gs_131:
s_mov_b64 exec, s[70:71]
s_cbranch_execz L_gs_132
buffer_load_dwordx4 v[84:87], v1, s[8:11], s46 offen offset:1024 sc1
L_gs_132:
s_mov_b64 exec, s[72:73]
s_cbranch_execz L_gs_133
buffer_load_dwordx4 v[88:91], v1, s[8:11], s46 offen offset:2048 sc1
L_gs_133:
s_mov_b64 s[36:37], 0
s_waitcnt vmcnt(0)
s_mov_b64 exec, s[60:61]
s_cbranch_execz L_gs_134
v_cmp_eq_u32 vcc, v20, v64
s_nop 0
s_mov_b64 s[60:61], vcc
s_or_b64 s[36:37], s[36:37], vcc
L_gs_134:
s_mov_b64 exec, s[62:63]
s_cbranch_execz L_gs_135
v_cmp_eq_u32 vcc, v20, v68
s_nop 0
s_mov_b64 s[62:63], vcc
s_or_b64 s[36:37], s[36:37], vcc
L_gs_135:
s_mov_b64 exec, s[64:65]
s_cbranch_execz L_gs_136
v_cmp_eq_u32 vcc, v20, v72
s_nop 0
s_mov_b64 s[64:65], vcc
s_or_b64 s[36:37], s[36:37], vcc
L_gs_136:
s_mov_b64 exec, s[66:67]
s_cbranch_execz L_gs_137
v_cmp_eq_u32 vcc, v20, v76
s_nop 0
s_mov_b64 s[66:67], vcc
s_or_b64 s[36:37], s[36:37], vcc
L_gs_137:
s_mov_b64 exec, s[68:69]
s_cbranch_execz L_gs_138
v_cmp_eq_u32 vcc, v20, v80
s_nop 0
s_mov_b64 s[68:69], vcc
s_or_b64 s[36:37], s[36:37], vcc
L_gs_138:
s_mov_b64 exec, s[70:71]
s_cbranch_execz L_gs_139
v_cmp_eq_u32 vcc, v20, v84
s_nop 0
s_mov_b64 s[70:71], vcc
s_or_b64 s[36:37], s[36:37], vcc
L_gs_139:
s_mov_b64 exec, s[72:73]
s_cbranch_execz L_gs_140
v_cmp_eq_u32 vcc, v20, v88
s_nop 0
s_mov_b64 s[72:73], vcc
s_or_b64 s[36:37], s[36:37], vcc
L_gs_140:
s_mov_b64 exec, -1
s_cmp_eq_u64 s[36:37], 0
s_cbranch_scc1 L_gd_126
s_sub_u32 s14, s14, 1
s_cbranch_scc0 L_g_124
L_gd_126:
v_pk_add_f32 v[64:65], v[64:65], v[68:69]
v_pk_add_f32 v[66:67], v[66:67], v[70:71]
v_pk_add_f32 v[72:73], v[72:73], v[76:77]
v_pk_add_f32 v[74:75], v[74:75], v[78:79]
v_pk_add_f32 v[80:81], v[80:81], v[84:85]
v_pk_add_f32 v[82:83], v[82:83], v[86:87]
v_pk_add_f32 v[64:65], v[64:65], v[72:73]
v_pk_add_f32 v[66:67], v[66:67], v[74:75]
v_pk_add_f32 v[80:81], v[80:81], v[88:89]
v_pk_add_f32 v[82:83], v[82:83], v[90:91]
v_pk_add_f32 v[64:65], v[64:65], v[80:81]
v_pk_add_f32 v[66:67], v[66:67], v[82:83]
s_nop 1
v_permlane32_swap_b32 v64, v66
v_permlane32_swap_b32 v65, v67
v_add_f32 v64, v64, v66
v_add_f32 v65, v65, v67
s_nop 1
v_permlane16_swap_b32 v64, v65
v_add_f32 v64, v64, v65
s_nop 1
v_add_f32_dpp v64, v64, v64 row_ror:8 row_mask:0xf bank_mask:0xf
v_cvt_pk_bf16_f32 v36, 0, v64
v_mul_f32 v36, v43, v36
v_cvt_pk_bf16_f32 v36, 0, v36
v_add_f32 v19, v19, v36
v_mov_b32 v36, v19
s_nop 1
v_permlane16_swap_b32 v19, v36
v_cvt_pk_bf16_f32 v36, v19, v36
v_mov_b32 v37, v36
s_nop 1
v_permlane32_swap_b32 v36, v37
s_mov_b64 exec, 0xff
buffer_store_dwordx2 v[36:37], v52, s[24:27], 0 offen
L_w_f5:
s_mov_b64 exec, -1
L_w_end:
L_end:
s_endpgm
L_codeend:
.section .rodata,"a"
.p2align 6
.amdhsa_kernel adaLN_cond__sliding_block_cached__geglu_ffn__decode_kernel
  .amdhsa_next_free_vgpr 256
  .amdhsa_next_free_sgpr 102
  .amdhsa_accum_offset 256
  .amdhsa_group_segment_fixed_size 0
  .amdhsa_kernarg_size 112
  .amdhsa_user_sgpr_count 2
  .amdhsa_user_sgpr_kernarg_segment_ptr 1
  .amdhsa_system_sgpr_workgroup_id_x 1
  .amdhsa_float_denorm_mode_32 3
.end_amdhsa_kernel
```
